```python
import torch

def _softmax(x, axis=-1):
    return torch.softmax(x, dim=axis)
def _gelu(x):
    return torch.nn.functional.gelu(x, approximate="tanh")
def _silu(x):
    return torch.nn.functional.silu(x)
def _sigmoid(x):
    return torch.sigmoid(x)
def _layernorm(x, axis=-1, eps=1e-5):
    m = x.mean(dim=axis, keepdim=True)
    v = x.var(dim=axis, keepdim=True, unbiased=False)
    return (x - m) / torch.sqrt(v + eps)
def _scatter_add(tgt, idx, src, axis=0):
    return tgt.clone().index_add_(axis, idx, src)
def _segment_sum(src, seg, n):
    out = torch.zeros((n,) + src.shape[1:], dtype=src.dtype)
    return out.index_add_(0, seg, src)
def _pad(x, pw):
    flat = tuple(v for pair in reversed(pw) for v in pair)
    return torch.nn.functional.pad(x, flat)

kernel_name = 'standalone__edge_featured_mpnn_egc__graph'

def setup_inputs():

    _w = (lambda a: (lambda t: t.to(torch.bfloat16) if t.is_floating_point() else t)(torch.as_tensor(a)))
    N, deg, D, De = 10000, 16, 256, max(16, 1)
    E = N * deg
    return {
        "x": _w((lambda *s: torch.randn(*s, dtype=torch.bfloat16) * 0.1)(N, D)),
        "e_attr": _w((lambda *s: torch.randn(*s, dtype=torch.bfloat16) * 0.1)(E, De)),
        "src": _w((lambda lo, hi, *s: torch.randint(lo, hi, s))(0, N, E).to(torch.int64)),
        "dst": _w((lambda lo, hi, *s: torch.randint(lo, hi, s))(0, N, E).to(torch.int64)),
        "u_w": _w((lambda *s: torch.randn(*s, dtype=torch.bfloat16) * 0.05)(D, D)),
        "v_w": _w((lambda *s: torch.randn(*s, dtype=torch.bfloat16) * 0.05)(D, D)),
        "g_w": _w((lambda *s: torch.randn(*s, dtype=torch.bfloat16) * 0.1)(2 * D + De, D)),
    }

def reference(x, e_attr, src, dst, u_w, v_w, g_w):
    N, D = x.shape
    g_in = torch.concatenate([x[dst], x[src], e_attr], axis=-1)
    eta = _sigmoid(g_in @ g_w)
    hv = x @ v_w
    msg = eta * hv[src]
    agg = _segment_sum(msg, dst, N)
    return _silu(x @ u_w + agg)
```

```asm
; @launch kernel=mpnn_fused_kernel grid=(256,1,1) block=(1024,1,1) lds=163840
.amdgcn_target "amdgcn-amd-amdhsa--gfx950"
.text
.globl mpnn_fused_kernel
.p2align 8
.type mpnn_fused_kernel,@function
mpnn_fused_kernel:
s_cmp_ge_u32 s2, 256
s_cbranch_scc1 K_END
s_load_dwordx16 s[4:19], s[0:1], 0
s_load_dwordx4 s[20:23], s[0:1], 64
s_getpc_b64 s[92:93]
K_PC:
s_lshr_b32 s94, s2, 3
s_mul_i32 s94, s94, 512
s_add_u32 s94, s94, 4096
v_subrev_u32 v60, 768, v0
v_lshlrev_b32 v60, 4, v60
v_subrev_u32 v62, 704, v0
v_lshlrev_b32 v62, 4, v62
v_add_u32 v62, s94, v62
v_cmp_le_u32 vcc, 768, v0
s_nop 1
v_cndmask_b32_e64 v60, v62, v60, vcc
v_min_u32 v60, CODE_END-K_PC-16, v60
v_mov_b32 v61, s93
v_add_co_u32 v60, vcc, s92, v60
s_nop 1
v_addc_co_u32 v61, vcc, 0, v61, vcc
v_cmp_le_u32 vcc, 704, v0
s_and_saveexec_b64 s[94:95], vcc
s_cbranch_execz K_PF_SKIP
global_load_dwordx4 v[56:59], v[60:61], off
K_PF_SKIP:
s_mov_b64 exec, s[94:95]
v_lshrrev_b32 v1, 6, v0
v_and_b32 v2, 63, v0
v_lshlrev_b32 v3, 2, v0
v_readfirstlane_b32 s24, v1
v_lshlrev_b32 v4, 4, v0
s_waitcnt lgkmcnt(0)
s_mul_i32 s72, s2, 2500
s_add_u32 s40, s10, s72
s_addc_u32 s41, s11, 0
s_and_b32 s41, s41, 0xffff
s_mov_b32 s42, 2500
s_mov_b32 s43, 0x00020000
buffer_load_dword v5, v3, s[40:43], 0 offen
s_add_u32 s44, s8, s72
s_addc_u32 s45, s9, 0
s_and_b32 s45, s45, 0xffff
s_mov_b32 s46, 2500
s_mov_b32 s47, 0x00020000
buffer_load_dword v7, v3, s[44:47], 0 offen
s_mul_i32 s72, s2, 20000
s_add_u32 s48, s6, s72
s_addc_u32 s49, s7, 0
s_and_b32 s49, s49, 0xffff
s_mov_b32 s50, 20000
s_mov_b32 s51, 0x00020000
s_movk_i32 s73, 0x4000
buffer_load_dwordx4 v[20:23], v4, s[48:51], 0 offen
buffer_load_dwordx4 v[24:27], v4, s[48:51], s73 offen
s_cmp_lg_u32 s2, 0
s_cbranch_scc1 K_NONCE_SKIP
s_cmp_lg_u32 s24, 13
s_cbranch_scc1 K_NONCE_SKIP
s_memrealtime s[92:93]
s_mov_b32 s72, s20
s_mov_b32 s73, s21
s_and_b32 s73, s73, 0xffff
s_mov_b32 s74, 256
s_mov_b32 s75, 0x00020000
s_waitcnt lgkmcnt(0)
s_or_b32 s92, s92, 1
v_mov_b32 v30, s92
v_mov_b32 v31, 32
buffer_store_dword v30, v31, s[72:75], 0 offen sc1
K_NONCE_SKIP:
s_and_b32 s72, s2, 7
s_lshr_b32 s73, s2, 3
s_and_b32 s74, s73, 7
s_lshr_b32 s25, s74, 1
s_and_b32 s26, s74, 1
s_lshr_b32 s75, s73, 3
s_lshl_b32 s76, s72, 2
s_add_u32 s76, s76, s75
s_mul_i32 s27, s76, 320
s_and_b32 s85, s72, 3
s_lshr_b32 s72, s72, 2
s_lshl_b32 s72, s72, 5
s_add_u32 s86, s73, s72
s_mul_i32 s87, s86, 157
s_sub_u32 s88, 10000, s87
s_min_u32 s88, s88, 157
s_mul_i32 s89, s24, 3
s_lshl_b32 s72, s24, 1
s_add_u32 s72, s72, 8
s_lshl_b32 s73, s24, 5
s_lshl_b32 s74, s24, 4
s_add_u32 s74, s74, 128
s_lshl_b32 s75, s24, 12
s_lshl_b32 s76, s24, 11
s_add_u32 s76, s76, 16384
s_cmp_lt_u32 s24, 8
s_cselect_b32 s89, s89, s72
s_cselect_b32 s90, 3, 2
s_cselect_b32 s73, s73, s74
s_cselect_b32 s75, s75, s76
s_add_u32 s28, s27, s73
s_add_u32 s29, s75, 65536
s_mov_b32 s81, 0xbfb8aa3b
s_mov_b32 s82, 0xd800000
s_mov_b32 s83, 0x07060100
v_mov_b32 v34, 0
v_lshlrev_b32 v35, 2, v2
v_add_u32 v36, 106496, v35
ds_write_b32 v36, v34
v_add_u32 v36, 163776, v35
v_cmp_gt_u32 vcc, 16, v2
s_and_saveexec_b64 s[94:95], vcc
ds_write_b32 v36, v34
s_mov_b64 exec, s[94:95]
s_waitcnt lgkmcnt(0)
s_barrier
s_mov_b32 s32, s4
s_mov_b32 s33, s5
s_and_b32 s33, s33, 0xffff
s_mov_b32 s34, 5120000
s_mov_b32 s35, 0x00020000
s_cmp_ge_u32 s24, 10
s_cbranch_scc1 K1_XPF_SKIP
s_lshr_b32 s72, s2, 3
s_and_b32 s72, s72, 7
s_mul_i32 s72, s72, 40
s_add_u32 s72, s72, s27
s_lshl_b32 s72, s72, 9
s_lshl_b32 s73, s24, 11
s_add_u32 s72, s72, s73
v_lshlrev_b32 v34, 4, v2
buffer_load_dwordx4 v[112:115], v34, s[32:35], s72 offen
buffer_load_dwordx4 v[116:119], v34, s[32:35], s72 offen offset:1024
K1_XPF_SKIP:
v_lshrrev_b32 v32, 3, v2
v_and_b32 v33, 7, v2
s_add_u32 s72, s16, 131072
s_addc_u32 s73, s17, 0
s_cmp_eq_u32 s26, 0
s_cselect_b32 s74, s72, s12
s_cselect_b32 s75, s73, s13
s_cselect_b32 s76, s14, s16
s_cselect_b32 s77, s15, s17
s_mov_b32 s36, s74
s_mov_b32 s37, s75
s_and_b32 s37, s37, 0xffff
s_mov_b32 s38, 131072
s_mov_b32 s39, 0x00020000
s_mov_b32 s68, s76
s_mov_b32 s69, s77
s_and_b32 s69, s69, 0xffff
s_mov_b32 s70, 131072
s_mov_b32 s71, 0x00020000
s_cmp_lt_u32 s24, 10
s_cbranch_scc1 K1_WPF_SKIP
v_lshlrev_b32 v34, 9, v32
v_lshl_add_u32 v34, v33, 4, v34
s_lshl_b32 s72, s25, 7
v_add_u32 v34, s72, v34
s_sub_u32 s72, s24, 10
s_mul_i32 s73, s72, 3
s_add_u32 s76, s73, 3
s_cmp_lt_u32 s24, 14
s_cbranch_scc1 K1_WPF_LOOP
s_lshl_b32 s73, s72, 1
s_add_u32 s73, s73, 4
s_add_u32 s76, s73, 2
K1_WPF_LOOP:
s_lshr_b32 s74, s2, 6
s_lshl_b32 s74, s74, 15
s_and_b32 s75, s73, 7
s_lshl_b32 s75, s75, 12
s_add_u32 s74, s74, s75
s_cmp_ge_u32 s73, 8
s_cbranch_scc1 K1_WPF_HI
buffer_load_dwordx4 v[112:115], v34, s[36:39], s74 offen
s_branch K1_WPF_NX
K1_WPF_HI:
buffer_load_dwordx4 v[112:115], v34, s[68:71], s74 offen
K1_WPF_NX:
s_add_u32 s73, s73, 1
s_cmp_lt_u32 s73, s76
s_cbranch_scc1 K1_WPF_LOOP
K1_WPF_SKIP:
v_lshrrev_b32 v34, 2, v32
v_lshlrev_b32 v34, 3, v34
v_and_b32 v35, 3, v32
v_add_u32 v34, v34, v35
v_lshlrev_b32 v34, 9, v34
v_lshrrev_b32 v35, 1, v33
v_lshrrev_b32 v36, 1, v32
v_xor_b32 v35, v35, v36
v_lshl_add_u32 v34, v35, 5, v34
v_and_b32 v35, 1, v33
v_lshl_add_u32 v34, v35, 4, v34
s_lshl_b32 s72, s25, 7
v_add_u32 v19, s72, v34
v_and_b32 v9, 15, v2
v_lshrrev_b32 v37, 4, v2
v_add_u32 v35, 0, v32
v_lshrrev_b32 v36, 1, v35
v_xor_b32 v36, v36, v33
v_lshlrev_b32 v36, 4, v36
v_lshl_add_u32 v10, v35, 9, v36
v_add_u32 v35, 8, v32
v_lshrrev_b32 v36, 1, v35
v_xor_b32 v36, v36, v33
v_lshlrev_b32 v36, 4, v36
v_lshl_add_u32 v11, v35, 9, v36
s_cmp_ge_u32 s24, 10
s_cbranch_scc1 K1_A1W
s_waitcnt vmcnt(4)
s_movk_i32 s72, 6679
v_mov_b32 v35, 1
v_mul_u32_u24 v32, s72, v5
v_lshrrev_b32 v32, 20, v32
v_lshlrev_b32 v34, 2, v32
v_add_u32 v36, 106496, v34
v_mul_u32_u24 v38, 157, v32
v_sub_u32 v38, v5, v38
v_lshl_or_b32 v38, v38, 16, v7
v_cmp_gt_u32 vcc, 625, v0
s_and_saveexec_b64 s[94:95], vcc
s_cbranch_execz K1_A1
ds_add_rtn_u32 v39, v36, v35
K1_A1:
s_mov_b64 exec, s[94:95]
K1_A1W:
v_add_u32 v40, 0, v37
v_lshrrev_b32 v41, 1, v9
v_xor_b32 v40, v40, v41
v_lshlrev_b32 v40, 4, v40
v_lshl_add_u32 v40, v9, 7, v40
v_add_u32 v12, s29, v40
v_add_u32 v40, 4, v37
v_lshrrev_b32 v41, 1, v9
v_xor_b32 v40, v40, v41
v_lshlrev_b32 v40, 4, v40
v_lshl_add_u32 v40, v9, 7, v40
v_add_u32 v13, s29, v40
v_lshrrev_b32 v40, 2, v9
v_lshl_add_u32 v40, v37, 2, v40
v_lshrrev_b32 v41, 1, v40
v_and_b32 v41, 3, v41
v_lshlrev_b32 v41, 5, v41
v_lshl_add_u32 v41, v40, 7, v41
v_and_b32 v40, 3, v9
v_lshl_add_u32 v14, v40, 3, v41
v_xor_b32 v15, 32, v14
v_xor_b32 v16, 64, v14
v_xor_b32 v17, 96, v14
v_lshlrev_b32 v18, 10, v37
v_lshl_add_u32 v18, v9, 4, v18
s_waitcnt lgkmcnt(0)
s_barrier
v_lshlrev_b32 v33, 2, v2
v_add_u32 v33, 106496, v33
ds_read_b32 v43, v33
s_mul_i32 s72, s2, 2560
s_add_u32 s52, s22, s72
s_addc_u32 s53, s23, 0
s_add_u32 s52, s52, 20971520
s_addc_u32 s53, s53, 0
s_and_b32 s53, s53, 0xffff
s_mov_b32 s54, 2560
s_mov_b32 s55, 0x00020000
s_mul_i32 s72, s2, 20480
s_add_u32 s56, s22, s72
s_addc_u32 s57, s23, 0
s_add_u32 s56, s56, 21626880
s_addc_u32 s57, s57, 0
s_and_b32 s57, s57, 0xffff
s_mov_b32 s58, 20480
s_mov_b32 s59, 0x00020000
s_add_u32 s60, s22, 26869888
s_addc_u32 s61, s23, 0
s_and_b32 s61, s61, 0xffff
s_mov_b32 s62, 65536
s_mov_b32 s63, 0x00020000
s_mul_i32 s72, s25, 2621440
s_mul_i32 s73, s26, 10485760
s_add_u32 s72, s72, s73
s_add_u32 s64, s22, s72
s_addc_u32 s65, s23, 0
s_and_b32 s65, s65, 0xffff
s_mov_b32 s66, 2560000
s_mov_b32 s67, 0x00020000
s_waitcnt lgkmcnt(0)
v_mov_b32 v44, v43
s_nop 1
v_add_u32_dpp v44, v44, v44 row_shr:1 row_mask:0xf bank_mask:0xf bound_ctrl:0
s_nop 1
v_add_u32_dpp v44, v44, v44 row_shr:2 row_mask:0xf bank_mask:0xf bound_ctrl:0
s_nop 1
v_add_u32_dpp v44, v44, v44 row_shr:4 row_mask:0xf bank_mask:0xf bound_ctrl:0
s_nop 1
v_add_u32_dpp v44, v44, v44 row_shr:8 row_mask:0xf bank_mask:0xf bound_ctrl:0
s_nop 1
v_add_u32_dpp v44, v44, v44 row_bcast:15 row_mask:0xa bank_mask:0xf
s_nop 1
v_add_u32_dpp v44, v44, v44 row_bcast:31 row_mask:0xc bank_mask:0xf
s_nop 1
v_sub_u32 v44, v44, v43
v_lshl_or_b32 v30, v43, 16, v44
s_cmp_ge_u32 s24, 10
s_cbranch_scc1 K1_A2W
ds_bpermute_b32 v47, v34, v44
v_add_u32 v49, 106752, v3
s_waitcnt lgkmcnt(0)
v_add_u32 v47, v47, v39
v_lshlrev_b32 v50, 2, v47
v_add_u32 v50, 109312, v50
v_cmp_gt_u32 vcc, 625, v0
s_and_saveexec_b64 s[94:95], vcc
s_cbranch_execz K1_A2
ds_write_b32 v50, v38
ds_write_b32 v49, v47
K1_A2:
s_mov_b64 exec, s[94:95]
K1_A2W:
s_waitcnt lgkmcnt(0)
s_barrier
v_lshrrev_b32 v50, 1, v0
v_lshlrev_b32 v50, 2, v50
v_add_u32 v50, 106752, v50
ds_read_b32 v51, v50
ds_read_b32 v52, v50 offset:2048
v_and_b32 v54, 1, v0
v_lshlrev_b32 v54, 4, v54
v_add_u32 v54, 111872, v54
s_waitcnt vmcnt(0)
K1_EW3:
s_waitcnt lgkmcnt(0)
v_lshl_add_u32 v51, v51, 5, v54
v_lshl_add_u32 v52, v52, 5, v54
ds_write_b128 v51, v[20:23]
v_cmp_gt_u32 vcc, 226, v0
s_and_saveexec_b64 s[94:95], vcc
s_cbranch_execz K1_A3
ds_write_b128 v52, v[24:27]
K1_A3:
s_mov_b64 exec, s[94:95]
s_and_b32 s72, s24, 7
s_lshl_b32 s72, s72, 14
s_lshl_b32 s74, s24, 12
s_cmp_ge_u32 s24, 8
s_cbranch_scc1 K1_W4HIL
s_add_u32 s73, s72, 0
s_add_u32 m0, s74, 0
s_nop 0
buffer_load_dwordx4 v19, s[36:39], s73 offen lds
s_add_u32 s73, s72, 8192
s_add_u32 m0, s74, 1024
s_nop 0
buffer_load_dwordx4 v19, s[36:39], s73 offen lds
s_add_u32 s73, s72, 2048
s_add_u32 m0, s74, 2048
s_nop 0
buffer_load_dwordx4 v19, s[36:39], s73 offen lds
s_add_u32 s73, s72, 10240
s_add_u32 m0, s74, 3072
s_nop 0
buffer_load_dwordx4 v19, s[36:39], s73 offen lds
s_branch K1_W4DL
K1_W4HIL:
s_add_u32 s73, s72, 0
s_add_u32 m0, s74, 0
s_nop 0
buffer_load_dwordx4 v19, s[68:71], s73 offen lds
s_add_u32 s73, s72, 8192
s_add_u32 m0, s74, 1024
s_nop 0
buffer_load_dwordx4 v19, s[68:71], s73 offen lds
s_add_u32 s73, s72, 2048
s_add_u32 m0, s74, 2048
s_nop 0
buffer_load_dwordx4 v19, s[68:71], s73 offen lds
s_add_u32 s73, s72, 10240
s_add_u32 m0, s74, 3072
s_nop 0
buffer_load_dwordx4 v19, s[68:71], s73 offen lds
K1_W4DL:
s_cmp_ge_u32 s24, 12
s_cbranch_scc1 K1_X0D
s_add_u32 s72, s28, 0
s_lshl_b32 s72, s72, 9
s_add_u32 m0, s29, 0
s_nop 0
buffer_load_dwordx4 v10, s[32:35], s72 offen lds
s_add_u32 m0, s29, 1024
s_nop 0
buffer_load_dwordx4 v11, s[32:35], s72 offen lds
s_cmp_ge_u32 s24, 8
s_cbranch_scc1 K1_X0D
s_add_u32 s72, s28, 16
s_lshl_b32 s72, s72, 9
s_add_u32 m0, s29, 2048
s_nop 0
buffer_load_dwordx4 v10, s[32:35], s72 offen lds
s_add_u32 m0, s29, 3072
s_nop 0
buffer_load_dwordx4 v11, s[32:35], s72 offen lds
K1_X0D:
s_cmp_ge_u32 s24, 12
s_cbranch_scc1 K1_F3W0
s_cmp_ge_u32 s24, 8
s_cbranch_scc1 K1_F3W2
s_waitcnt vmcnt(4)
s_branch K1_F3WD
K1_F3W2:
s_waitcnt vmcnt(2)
s_branch K1_F3WD
K1_F3W0:
s_waitcnt vmcnt(0)
K1_F3WD:
s_waitcnt lgkmcnt(0)
s_barrier
s_cmp_lt_u32 s24, 12
s_cbranch_scc1 K1_GEMM
s_setprio 3
v_subrev_u32 v40, 768, v0
v_lshlrev_b32 v41, 4, v40
v_add_u32 v42, 111872, v41
v_add_u32 v43, 109312, v41
ds_read_b128 v[44:47], v42 offset:0
ds_read_b128 v[48:51], v42 offset:4096
ds_read_b128 v[52:55], v42 offset:8192
ds_read_b128 v[56:59], v42 offset:12288
ds_read_b128 v[60:63], v42 offset:16384
ds_read_b128 v[64:67], v43
s_mov_b32 s32, s20
s_mov_b32 s33, s21
s_and_b32 s33, s33, 0xffff
s_mov_b32 s34, 256
s_mov_b32 s35, 0x00020000
v_mov_b32 v68, 32
s_cmp_lg_u32 s24, 12
s_cbranch_scc1 KN_LD_SKIP
buffer_load_dword v69, v68, s[32:35], 0 offen sc1
KN_LD_SKIP:
s_waitcnt lgkmcnt(0)
s_movk_i32 s72, 0
buffer_store_dwordx4 v[44:47], v41, s[56:59], s72 offen sc1
s_movk_i32 s72, 4096
buffer_store_dwordx4 v[48:51], v41, s[56:59], s72 offen sc1
s_movk_i32 s72, 8192
buffer_store_dwordx4 v[52:55], v41, s[56:59], s72 offen sc1
s_movk_i32 s72, 12288
buffer_store_dwordx4 v[56:59], v41, s[56:59], s72 offen sc1
s_movk_i32 s72, 16384
buffer_store_dwordx4 v[60:63], v41, s[56:59], s72 offen sc1
buffer_store_dwordx4 v[64:67], v41, s[52:55], 0 offen sc1
s_branch K1_OT
s_cmp_lg_u32 s24, 12
s_cbranch_scc1 K1_OT
v_lshlrev_b32 v31, 10, v2
s_lshl_b32 s72, s2, 2
buffer_store_dword v30, v31, s[60:63], s72 offen sc1
K1_OT:
s_cmp_ge_u32 s2, 5
s_cbranch_scc1 K1_Z
s_cmp_lg_u32 s24, 14
s_cbranch_scc1 K1_Z
s_mul_i32 s72, s2, 2621440
s_add_u32 s72, s72, 2560000
s_mov_b32 s73, 26869760
s_movk_i32 s74, 256
s_cmp_eq_u32 s2, 4
s_cselect_b32 s72, s73, s72
s_cselect_b32 s73, 64, s74
s_add_u32 s76, s22, s72
s_addc_u32 s77, s23, 0
s_and_b32 s77, s77, 0xffff
s_mov_b32 s78, s73
s_mov_b32 s79, 0x00020000
v_mov_b32 v72, 0
v_mov_b32 v73, 0
v_mov_b32 v74, 0
v_mov_b32 v75, 0
v_lshlrev_b32 v76, 4, v2
buffer_store_dwordx4 v[72:75], v76, s[76:79], 0 offen sc1
K1_Z:
s_waitcnt lgkmcnt(0)
v_mov_b32 v120, 163776
v_mov_b32 v121, 1
s_mov_b64 s[94:95], exec
s_mov_b64 exec, 1
ds_add_u32 v120, v121
s_mov_b64 exec, s[94:95]
KQ_SPIN0:
ds_read_b32 v121, v120
s_waitcnt lgkmcnt(0)
v_readfirstlane_b32 s96, v121
s_nop 3
s_cmp_ge_u32 s96, 4
s_cbranch_scc1 KQ_DONE0
s_sleep 1
s_branch KQ_SPIN0
KQ_DONE0:
v_mov_b32 v4, 131072
v_mov_b32 v44, 0
v_mov_b32 v48, 0x27102710
v_mov_b32 v52, 0xae00ae0
v_mov_b32 v45, 0
v_mov_b32 v49, 0x27102710
v_mov_b32 v53, 0xae00ae0
v_mov_b32 v46, 0
v_mov_b32 v50, 0x27102710
v_mov_b32 v54, 0xae00ae0
v_mov_b32 v47, 0
v_mov_b32 v51, 0x27102710
v_mov_b32 v55, 0xae00ae0
v_add_u32 v42, v4, v41
v_cmp_gt_u32 vcc, 80, v40
s_and_saveexec_b64 s[94:95], vcc
ds_write_b128 v42, v[44:47]
s_mov_b64 exec, s[94:95]
ds_write_b128 v42, v[48:51] offset:6144
ds_write_b128 v42, v[52:55] offset:13312
v_cmp_gt_u32 vcc, 192, v40
s_and_saveexec_b64 s[94:95], vcc
ds_write_b128 v42, v[48:51] offset:10240
ds_write_b128 v42, v[52:55] offset:17408
s_mov_b64 exec, s[94:95]
s_add_u32 s36, s22, 26869888
s_addc_u32 s37, s23, 0
s_and_b32 s37, s37, 0xffff
s_mov_b32 s38, 65536
s_mov_b32 s39, 0x00020000
s_add_u32 s40, s22, 20971520
s_addc_u32 s41, s23, 0
s_and_b32 s41, s41, 0xffff
s_mov_b32 s42, 655360
s_mov_b32 s43, 0x00020000
s_mov_b32 s44, s16
s_mov_b32 s45, s17
s_and_b32 s45, s45, 0xffff
s_mov_b32 s46, 270336
s_mov_b32 s47, 0x00020000
s_cmp_lg_u32 s24, 15
s_cbranch_scc1 K2_C_SKIP
v_lshrrev_b32 v44, 3, v2
v_lshlrev_b32 v44, 9, v44
v_and_b32 v45, 7, v2
v_lshl_add_u32 v44, v45, 4, v44
s_lshl_b32 s72, s85, 7
s_add_u32 s72, s72, 262144
s_mov_b32 m0, 135168
s_nop 0
buffer_load_dwordx4 v44, s[44:47], s72 offen lds
s_add_u32 s72, s72, 4096
s_mov_b32 m0, 136192
s_nop 0
buffer_load_dwordx4 v44, s[44:47], s72 offen lds
K2_C_SKIP:
s_waitcnt vmcnt(0)
s_add_u32 s48, s22, 27984000
s_addc_u32 s49, s23, 0
s_and_b32 s49, s49, 0xffff
s_mov_b32 s50, 10240
s_mov_b32 s51, 0x00020000
s_waitcnt lgkmcnt(0)
v_mov_b32 v120, 163780
v_mov_b32 v121, 1
s_mov_b64 s[94:95], exec
s_mov_b64 exec, 1
ds_add_u32 v120, v121
s_mov_b64 exec, s[94:95]
KQ_SPIN1:
ds_read_b32 v121, v120
s_waitcnt lgkmcnt(0)
v_readfirstlane_b32 s96, v121
s_nop 3
s_cmp_ge_u32 s96, 4
s_cbranch_scc1 KQ_DONE1
s_sleep 1
s_branch KQ_SPIN1
KQ_DONE1:
s_cmp_lg_u32 s24, 12
s_cbranch_scc1 KF_SIGA
s_mov_b32 s97, 0x4000
KN_SPIN:
v_readfirstlane_b32 s84, v69
s_sub_u32 s97, s97, 1
s_cmp_eq_u32 s97, 0
s_cbranch_scc1 KN_OK
s_cmp_lg_u32 s84, 0
s_cbranch_scc1 KN_OK
s_sleep 16
buffer_load_dword v69, v68, s[32:35], 0 offen sc1
s_waitcnt vmcnt(0)
s_branch KN_SPIN
KN_OK:
v_mov_b32 v120, 163828
v_mov_b32 v121, s84
ds_write_b32 v120, v121
s_add_u32 s36, s22, 28000384
s_addc_u32 s37, s23, 0
s_and_b32 s37, s37, 0xffff
s_mov_b32 s38, 131072
s_mov_b32 s39, 0x00020000
v_mov_b32 v31, s84
v_lshlrev_b32 v120, 11, v2
s_lshl_b32 s72, s2, 3
buffer_store_dwordx2 v[30:31], v120, s[36:39], s72 offen sc1
KF_SIGA:
s_waitcnt lgkmcnt(0)
v_mov_b32 v120, 163784
v_mov_b32 v121, 1
s_mov_b64 s[94:95], exec
s_mov_b64 exec, 1
ds_add_u32 v120, v121
s_mov_b64 exec, s[94:95]
KQ_SPIN2:
ds_read_b32 v121, v120
s_waitcnt lgkmcnt(0)
v_readfirstlane_b32 s96, v121
s_nop 3
s_cmp_ge_u32 s96, 4
s_cbranch_scc1 KQ_DONE2
s_sleep 1
s_branch KQ_SPIN2
KQ_DONE2:
v_mov_b32 v120, 163828
ds_read_b32 v121, v120
s_add_u32 s36, s22, 28000384
s_addc_u32 s37, s23, 0
s_and_b32 s37, s37, 0xffff
s_mov_b32 s38, 131072
s_mov_b32 s39, 0x00020000
v_lshlrev_b32 v41, 3, v40
s_lshl_b32 s72, s86, 11
s_mov_b32 s97, 0x4000
s_waitcnt lgkmcnt(0)
v_readfirstlane_b32 s96, v121
KT_POLL:
buffer_load_dwordx2 v[6:7], v41, s[36:39], s72 offen sc1
s_waitcnt vmcnt(0)
v_cmp_ne_u32 vcc, s96, v7
s_cbranch_vccz KT_DONE
s_sub_u32 s97, s97, 1
s_cmp_eq_u32 s97, 0
s_cbranch_scc1 KT_DONE
s_sleep 6
s_branch KT_POLL
KT_DONE:
v_and_b32 v7, 0xffff, v6
v_lshrrev_b32 v6, 16, v6
v_mul_u32_u24 v8, 640, v40
v_add_u32 v7, v7, v8
v_mov_b32 v8, v6
s_nop 1
v_add_u32_dpp v8, v8, v8 row_shr:1 row_mask:0xf bank_mask:0xf bound_ctrl:0
s_nop 1
v_add_u32_dpp v8, v8, v8 row_shr:2 row_mask:0xf bank_mask:0xf bound_ctrl:0
s_nop 1
v_add_u32_dpp v8, v8, v8 row_shr:4 row_mask:0xf bank_mask:0xf bound_ctrl:0
s_nop 1
v_add_u32_dpp v8, v8, v8 row_shr:8 row_mask:0xf bank_mask:0xf bound_ctrl:0
s_nop 1
v_add_u32_dpp v8, v8, v8 row_bcast:15 row_mask:0xa bank_mask:0xf
s_nop 1
v_add_u32_dpp v8, v8, v8 row_bcast:31 row_mask:0xc bank_mask:0xf
s_nop 1
v_readlane_b32 s72, v8, 63
v_sub_u32 v8, v8, v6
s_sub_u32 s73, s24, 12
s_lshl_b32 s73, s73, 2
s_add_u32 s73, s73, 131776
v_mov_b32 v9, s73
v_mov_b32 v10, s72
ds_write_b32 v9, v10
s_waitcnt lgkmcnt(0)
v_mov_b32 v120, 163788
v_mov_b32 v121, 1
s_mov_b64 s[94:95], exec
s_mov_b64 exec, 1
ds_add_u32 v120, v121
s_mov_b64 exec, s[94:95]
KQ_SPIN3:
ds_read_b32 v121, v120
s_waitcnt lgkmcnt(0)
v_readfirstlane_b32 s96, v121
s_nop 3
s_cmp_ge_u32 s96, 4
s_cbranch_scc1 KQ_DONE3
s_sleep 1
s_branch KQ_SPIN3
KQ_DONE3:
ds_read_b128 v[12:15], v4 offset:704
s_waitcnt lgkmcnt(0)
v_readfirstlane_b32 s72, v12
v_readfirstlane_b32 s73, v13
v_readfirstlane_b32 s74, v14
v_readfirstlane_b32 s75, v15
s_nop 3
s_add_u32 s73, s72, s73
s_add_u32 s74, s73, s74
s_add_u32 s91, s74, s75
s_mov_b32 s75, 0
s_cmp_eq_u32 s24, 13
s_cselect_b32 s75, s72, s75
s_cmp_eq_u32 s24, 14
s_cselect_b32 s75, s73, s75
s_cmp_eq_u32 s24, 15
s_cselect_b32 s75, s74, s75
v_mov_b32 v9, s91
ds_write_b32 v4, v9 offset:720
v_mov_b32 v13, 1
s_cmp_le_u32 s91, 2783
s_cbranch_scc1 K2_TOT_OK
ds_write_b32 v4, v13 offset:700
s_branch K1_GDONE
K2_TOT_OK:
v_add_u32 v8, s75, v8
v_lshl_add_u32 v8, v8, 2, v4
v_mov_b32 v12, 0
s_mov_b64 s[94:95], exec
K2_EXP:
v_cmp_gt_u32 vcc, v6, v12
s_and_b64 exec, exec, vcc
s_cbranch_execz K2_EXP_DONE
ds_write_b32 v8, v7 offset:20480
v_add_u32 v7, 1, v7
v_add_u32 v12, 1, v12
v_cmp_gt_u32 vcc, v6, v12
s_and_b64 exec, exec, vcc
s_cbranch_execz K2_EXP_DONE
ds_write_b32 v8, v7 offset:20484
v_add_u32 v7, 1, v7
v_add_u32 v12, 1, v12
v_cmp_gt_u32 vcc, v6, v12
s_and_b64 exec, exec, vcc
s_cbranch_execz K2_EXP_DONE
ds_write_b32 v8, v7 offset:20488
v_add_u32 v7, 1, v7
v_add_u32 v12, 1, v12
v_cmp_gt_u32 vcc, v6, v12
s_and_b64 exec, exec, vcc
s_cbranch_execz K2_EXP_DONE
ds_write_b32 v8, v7 offset:20492
v_add_u32 v7, 1, v7
v_add_u32 v12, 1, v12
v_add_u32 v8, 16, v8
s_branch K2_EXP
K2_EXP_DONE:
s_mov_b64 exec, s[94:95]
s_branch K1_GDONE
K1_GEMM:
s_cmp_ge_u32 s24, 8
s_cbranch_scc1 K1_G1
v_pk_mov_b32 v[62:63], 0, 0
v_pk_mov_b32 v[64:65], 0, 0
v_pk_mov_b32 v[66:67], 0, 0
v_pk_mov_b32 v[68:69], 0, 0
v_pk_mov_b32 v[70:71], 0, 0
v_pk_mov_b32 v[72:73], 0, 0
v_pk_mov_b32 v[74:75], 0, 0
v_pk_mov_b32 v[76:77], 0, 0
v_pk_mov_b32 v[78:79], 0, 0
v_pk_mov_b32 v[80:81], 0, 0
v_pk_mov_b32 v[82:83], 0, 0
v_pk_mov_b32 v[84:85], 0, 0
v_pk_mov_b32 v[86:87], 0, 0
v_pk_mov_b32 v[88:89], 0, 0
v_pk_mov_b32 v[90:91], 0, 0
v_pk_mov_b32 v[92:93], 0, 0
v_pk_mov_b32 v[94:95], 0, 0
v_pk_mov_b32 v[96:97], 0, 0
v_pk_mov_b32 v[98:99], 0, 0
v_pk_mov_b32 v[100:101], 0, 0
v_pk_mov_b32 v[102:103], 0, 0
v_pk_mov_b32 v[104:105], 0, 0
v_pk_mov_b32 v[106:107], 0, 0
v_pk_mov_b32 v[108:109], 0, 0
v_pk_mov_b32 v[110:111], 0, 0
v_pk_mov_b32 v[112:113], 0, 0
v_pk_mov_b32 v[114:115], 0, 0
v_pk_mov_b32 v[116:117], 0, 0
v_pk_mov_b32 v[118:119], 0, 0
v_pk_mov_b32 v[120:121], 0, 0
v_pk_mov_b32 v[122:123], 0, 0
v_pk_mov_b32 v[124:125], 0, 0
s_mov_b32 s30, 0
s_lshl_b32 s31, s28, 9
K1_QA:
s_waitcnt vmcnt(0)
ds_read_b128 v[20:23], v12 offset:0
ds_read_b128 v[24:27], v13 offset:0
ds_read_b128 v[28:31], v12 offset:2048
ds_read_b128 v[32:35], v13 offset:2048
ds_read_b64_tr_b16 v[36:37], v14 offset:0
ds_read_b64_tr_b16 v[38:39], v14 offset:2048
ds_read_b64_tr_b16 v[40:41], v15 offset:0
ds_read_b64_tr_b16 v[42:43], v15 offset:2048
ds_read_b64_tr_b16 v[44:45], v16 offset:0
ds_read_b64_tr_b16 v[46:47], v16 offset:2048
ds_read_b64_tr_b16 v[48:49], v17 offset:0
ds_read_b64_tr_b16 v[50:51], v17 offset:2048
ds_read_b64_tr_b16 v[52:53], v14 offset:32768
ds_read_b64_tr_b16 v[54:55], v14 offset:34816
s_add_u32 s31, s31, 128
s_cmp_eq_u32 s30, 3
s_waitcnt lgkmcnt(10)
s_cbranch_scc1 K1_QXA
s_add_u32 s72, s31, 0
s_add_u32 m0, s29, 0
s_nop 0
buffer_load_dwordx4 v10, s[32:35], s72 offen lds
s_add_u32 m0, s29, 1024
s_nop 0
buffer_load_dwordx4 v11, s[32:35], s72 offen lds
s_add_u32 s72, s31, 8192
s_add_u32 m0, s29, 2048
s_nop 0
buffer_load_dwordx4 v10, s[32:35], s72 offen lds
s_add_u32 m0, s29, 3072
s_nop 0
buffer_load_dwordx4 v11, s[32:35], s72 offen lds
K1_QXA:
s_waitcnt lgkmcnt(8)
v_mfma_f32_16x16x32_bf16 v[62:65], v[20:23], v[36:39], v[62:65]
v_mfma_f32_16x16x32_bf16 v[94:97], v[28:31], v[36:39], v[94:97]
ds_read_b64_tr_b16 v[56:57], v15 offset:32768
ds_read_b64_tr_b16 v[58:59], v15 offset:34816
s_waitcnt lgkmcnt(8)
v_mfma_f32_16x16x32_bf16 v[66:69], v[20:23], v[40:43], v[66:69]
v_mfma_f32_16x16x32_bf16 v[98:101], v[28:31], v[40:43], v[98:101]
ds_read_b64_tr_b16 v[36:37], v16 offset:32768
ds_read_b64_tr_b16 v[38:39], v16 offset:34816
s_waitcnt lgkmcnt(8)
v_mfma_f32_16x16x32_bf16 v[70:73], v[20:23], v[44:47], v[70:73]
v_mfma_f32_16x16x32_bf16 v[102:105], v[28:31], v[44:47], v[102:105]
ds_read_b64_tr_b16 v[40:41], v17 offset:32768
ds_read_b64_tr_b16 v[42:43], v17 offset:34816
s_waitcnt lgkmcnt(8)
v_mfma_f32_16x16x32_bf16 v[74:77], v[20:23], v[48:51], v[74:77]
v_mfma_f32_16x16x32_bf16 v[106:109], v[28:31], v[48:51], v[106:109]
ds_read_b64_tr_b16 v[44:45], v14 offset:4096
ds_read_b64_tr_b16 v[46:47], v14 offset:6144
s_waitcnt lgkmcnt(8)
v_mfma_f32_16x16x32_bf16 v[78:81], v[20:23], v[52:55], v[78:81]
v_mfma_f32_16x16x32_bf16 v[110:113], v[28:31], v[52:55], v[110:113]
ds_read_b64_tr_b16 v[48:49], v15 offset:4096
ds_read_b64_tr_b16 v[50:51], v15 offset:6144
s_waitcnt lgkmcnt(8)
v_mfma_f32_16x16x32_bf16 v[82:85], v[20:23], v[56:59], v[82:85]
v_mfma_f32_16x16x32_bf16 v[114:117], v[28:31], v[56:59], v[114:117]
ds_read_b64_tr_b16 v[52:53], v16 offset:4096
ds_read_b64_tr_b16 v[54:55], v16 offset:6144
s_waitcnt lgkmcnt(8)
v_mfma_f32_16x16x32_bf16 v[86:89], v[20:23], v[36:39], v[86:89]
v_mfma_f32_16x16x32_bf16 v[118:121], v[28:31], v[36:39], v[118:121]
ds_read_b64_tr_b16 v[56:57], v17 offset:4096
ds_read_b64_tr_b16 v[58:59], v17 offset:6144
s_waitcnt lgkmcnt(8)
v_mfma_f32_16x16x32_bf16 v[90:93], v[20:23], v[40:43], v[90:93]
v_mfma_f32_16x16x32_bf16 v[122:125], v[28:31], v[40:43], v[122:125]
ds_read_b64_tr_b16 v[36:37], v14 offset:36864
ds_read_b64_tr_b16 v[38:39], v14 offset:38912
s_waitcnt lgkmcnt(8)
v_mfma_f32_16x16x32_bf16 v[62:65], v[24:27], v[44:47], v[62:65]
v_mfma_f32_16x16x32_bf16 v[94:97], v[32:35], v[44:47], v[94:97]
ds_read_b64_tr_b16 v[40:41], v15 offset:36864
ds_read_b64_tr_b16 v[42:43], v15 offset:38912
s_waitcnt lgkmcnt(8)
v_mfma_f32_16x16x32_bf16 v[66:69], v[24:27], v[48:51], v[66:69]
v_mfma_f32_16x16x32_bf16 v[98:101], v[32:35], v[48:51], v[98:101]
ds_read_b64_tr_b16 v[44:45], v16 offset:36864
ds_read_b64_tr_b16 v[46:47], v16 offset:38912
s_waitcnt lgkmcnt(8)
v_mfma_f32_16x16x32_bf16 v[70:73], v[24:27], v[52:55], v[70:73]
v_mfma_f32_16x16x32_bf16 v[102:105], v[32:35], v[52:55], v[102:105]
ds_read_b64_tr_b16 v[48:49], v17 offset:36864
ds_read_b64_tr_b16 v[50:51], v17 offset:38912
s_waitcnt lgkmcnt(8)
v_mfma_f32_16x16x32_bf16 v[74:77], v[24:27], v[56:59], v[74:77]
v_mfma_f32_16x16x32_bf16 v[106:109], v[32:35], v[56:59], v[106:109]
s_waitcnt lgkmcnt(6)
v_mfma_f32_16x16x32_bf16 v[78:81], v[24:27], v[36:39], v[78:81]
v_mfma_f32_16x16x32_bf16 v[110:113], v[32:35], v[36:39], v[110:113]
s_waitcnt lgkmcnt(4)
v_mfma_f32_16x16x32_bf16 v[82:85], v[24:27], v[40:43], v[82:85]
v_mfma_f32_16x16x32_bf16 v[114:117], v[32:35], v[40:43], v[114:117]
s_waitcnt lgkmcnt(2)
v_mfma_f32_16x16x32_bf16 v[86:89], v[24:27], v[44:47], v[86:89]
v_mfma_f32_16x16x32_bf16 v[118:121], v[32:35], v[44:47], v[118:121]
s_waitcnt lgkmcnt(0)
v_mfma_f32_16x16x32_bf16 v[90:93], v[24:27], v[48:51], v[90:93]
v_mfma_f32_16x16x32_bf16 v[122:125], v[32:35], v[48:51], v[122:125]
v_add_u32 v14, 8192, v14
v_add_u32 v15, 8192, v15
v_add_u32 v16, 8192, v16
v_add_u32 v17, 8192, v17
s_add_u32 s30, s30, 1
s_cmp_lt_u32 s30, 4
s_cbranch_scc1 K1_QA
s_nop 8
s_cmp_lg_u32 s26, 0
s_cbranch_scc1 K1_EPI1A
s_add_u32 s72, s28, 0
s_lshl_b32 s72, s72, 8
v_mul_f32 v20, s81, v62
v_add_f32 v21, s82, v78
v_cvt_f16_f32 v20, v20
v_add_u32 v21, 0x8000, v21
v_sub_u32 v21, v21, v20
v_perm_b32 v36, v21, v20, s83
v_mul_f32 v22, s81, v66
v_add_f32 v23, s82, v82
v_cvt_f16_f32 v22, v22
v_add_u32 v23, 0x8000, v23
v_sub_u32 v23, v23, v22
v_perm_b32 v37, v23, v22, s83
v_mul_f32 v24, s81, v70
v_add_f32 v25, s82, v86
v_cvt_f16_f32 v24, v24
v_add_u32 v25, 0x8000, v25
v_sub_u32 v25, v25, v24
v_perm_b32 v38, v25, v24, s83
v_mul_f32 v26, s81, v74
v_add_f32 v27, s82, v90
v_cvt_f16_f32 v26, v26
v_add_u32 v27, 0x8000, v27
v_sub_u32 v27, v27, v26
v_perm_b32 v39, v27, v26, s83
buffer_store_dwordx4 v[36:39], v18, s[64:67], s72 offen offset:0 sc1
v_mul_f32 v20, s81, v63
v_add_f32 v21, s82, v79
v_cvt_f16_f32 v20, v20
v_add_u32 v21, 0x8000, v21
v_sub_u32 v21, v21, v20
v_perm_b32 v40, v21, v20, s83
v_mul_f32 v22, s81, v67
v_add_f32 v23, s82, v83
v_cvt_f16_f32 v22, v22
v_add_u32 v23, 0x8000, v23
v_sub_u32 v23, v23, v22
v_perm_b32 v41, v23, v22, s83
v_mul_f32 v24, s81, v71
v_add_f32 v25, s82, v87
v_cvt_f16_f32 v24, v24
v_add_u32 v25, 0x8000, v25
v_sub_u32 v25, v25, v24
v_perm_b32 v42, v25, v24, s83
v_mul_f32 v26, s81, v75
v_add_f32 v27, s82, v91
v_cvt_f16_f32 v26, v26
v_add_u32 v27, 0x8000, v27
v_sub_u32 v27, v27, v26
v_perm_b32 v43, v27, v26, s83
buffer_store_dwordx4 v[40:43], v18, s[64:67], s72 offen offset:256 sc1
v_mul_f32 v20, s81, v64
v_add_f32 v21, s82, v80
v_cvt_f16_f32 v20, v20
v_add_u32 v21, 0x8000, v21
v_sub_u32 v21, v21, v20
v_perm_b32 v44, v21, v20, s83
v_mul_f32 v22, s81, v68
v_add_f32 v23, s82, v84
v_cvt_f16_f32 v22, v22
v_add_u32 v23, 0x8000, v23
v_sub_u32 v23, v23, v22
v_perm_b32 v45, v23, v22, s83
v_mul_f32 v24, s81, v72
v_add_f32 v25, s82, v88
v_cvt_f16_f32 v24, v24
v_add_u32 v25, 0x8000, v25
v_sub_u32 v25, v25, v24
v_perm_b32 v46, v25, v24, s83
v_mul_f32 v26, s81, v76
v_add_f32 v27, s82, v92
v_cvt_f16_f32 v26, v26
v_add_u32 v27, 0x8000, v27
v_sub_u32 v27, v27, v26
v_perm_b32 v47, v27, v26, s83
buffer_store_dwordx4 v[44:47], v18, s[64:67], s72 offen offset:512 sc1
v_mul_f32 v20, s81, v65
v_add_f32 v21, s82, v81
v_cvt_f16_f32 v20, v20
v_add_u32 v21, 0x8000, v21
v_sub_u32 v21, v21, v20
v_perm_b32 v48, v21, v20, s83
v_mul_f32 v22, s81, v69
v_add_f32 v23, s82, v85
v_cvt_f16_f32 v22, v22
v_add_u32 v23, 0x8000, v23
v_sub_u32 v23, v23, v22
v_perm_b32 v49, v23, v22, s83
v_mul_f32 v24, s81, v73
v_add_f32 v25, s82, v89
v_cvt_f16_f32 v24, v24
v_add_u32 v25, 0x8000, v25
v_sub_u32 v25, v25, v24
v_perm_b32 v50, v25, v24, s83
v_mul_f32 v26, s81, v77
v_add_f32 v27, s82, v93
v_cvt_f16_f32 v26, v26
v_add_u32 v27, 0x8000, v27
v_sub_u32 v27, v27, v26
v_perm_b32 v51, v27, v26, s83
buffer_store_dwordx4 v[48:51], v18, s[64:67], s72 offen offset:768 sc1
s_add_u32 s72, s28, 16
s_lshl_b32 s72, s72, 8
v_mul_f32 v20, s81, v94
v_add_f32 v21, s82, v110
v_cvt_f16_f32 v20, v20
v_add_u32 v21, 0x8000, v21
v_sub_u32 v21, v21, v20
v_perm_b32 v52, v21, v20, s83
v_mul_f32 v22, s81, v98
v_add_f32 v23, s82, v114
v_cvt_f16_f32 v22, v22
v_add_u32 v23, 0x8000, v23
v_sub_u32 v23, v23, v22
v_perm_b32 v53, v23, v22, s83
v_mul_f32 v24, s81, v102
v_add_f32 v25, s82, v118
v_cvt_f16_f32 v24, v24
v_add_u32 v25, 0x8000, v25
v_sub_u32 v25, v25, v24
v_perm_b32 v54, v25, v24, s83
v_mul_f32 v26, s81, v106
v_add_f32 v27, s82, v122
v_cvt_f16_f32 v26, v26
v_add_u32 v27, 0x8000, v27
v_sub_u32 v27, v27, v26
v_perm_b32 v55, v27, v26, s83
buffer_store_dwordx4 v[52:55], v18, s[64:67], s72 offen offset:0 sc1
v_mul_f32 v20, s81, v95
v_add_f32 v21, s82, v111
v_cvt_f16_f32 v20, v20
v_add_u32 v21, 0x8000, v21
v_sub_u32 v21, v21, v20
v_perm_b32 v56, v21, v20, s83
v_mul_f32 v22, s81, v99
v_add_f32 v23, s82, v115
v_cvt_f16_f32 v22, v22
v_add_u32 v23, 0x8000, v23
v_sub_u32 v23, v23, v22
v_perm_b32 v57, v23, v22, s83
v_mul_f32 v24, s81, v103
v_add_f32 v25, s82, v119
v_cvt_f16_f32 v24, v24
v_add_u32 v25, 0x8000, v25
v_sub_u32 v25, v25, v24
v_perm_b32 v58, v25, v24, s83
v_mul_f32 v26, s81, v107
v_add_f32 v27, s82, v123
v_cvt_f16_f32 v26, v26
v_add_u32 v27, 0x8000, v27
v_sub_u32 v27, v27, v26
v_perm_b32 v59, v27, v26, s83
buffer_store_dwordx4 v[56:59], v18, s[64:67], s72 offen offset:256 sc1
v_mul_f32 v20, s81, v96
v_add_f32 v21, s82, v112
v_cvt_f16_f32 v20, v20
v_add_u32 v21, 0x8000, v21
v_sub_u32 v21, v21, v20
v_perm_b32 v36, v21, v20, s83
v_mul_f32 v22, s81, v100
v_add_f32 v23, s82, v116
v_cvt_f16_f32 v22, v22
v_add_u32 v23, 0x8000, v23
v_sub_u32 v23, v23, v22
v_perm_b32 v37, v23, v22, s83
v_mul_f32 v24, s81, v104
v_add_f32 v25, s82, v120
v_cvt_f16_f32 v24, v24
v_add_u32 v25, 0x8000, v25
v_sub_u32 v25, v25, v24
v_perm_b32 v38, v25, v24, s83
v_mul_f32 v26, s81, v108
v_add_f32 v27, s82, v124
v_cvt_f16_f32 v26, v26
v_add_u32 v27, 0x8000, v27
v_sub_u32 v27, v27, v26
v_perm_b32 v39, v27, v26, s83
buffer_store_dwordx4 v[36:39], v18, s[64:67], s72 offen offset:512 sc1
v_mul_f32 v20, s81, v97
v_add_f32 v21, s82, v113
v_cvt_f16_f32 v20, v20
v_add_u32 v21, 0x8000, v21
v_sub_u32 v21, v21, v20
v_perm_b32 v40, v21, v20, s83
v_mul_f32 v22, s81, v101
v_add_f32 v23, s82, v117
v_cvt_f16_f32 v22, v22
v_add_u32 v23, 0x8000, v23
v_sub_u32 v23, v23, v22
v_perm_b32 v41, v23, v22, s83
v_mul_f32 v24, s81, v105
v_add_f32 v25, s82, v121
v_cvt_f16_f32 v24, v24
v_add_u32 v25, 0x8000, v25
v_sub_u32 v25, v25, v24
v_perm_b32 v42, v25, v24, s83
v_mul_f32 v26, s81, v109
v_add_f32 v27, s82, v125
v_cvt_f16_f32 v26, v26
v_add_u32 v27, 0x8000, v27
v_sub_u32 v27, v27, v26
v_perm_b32 v43, v27, v26, s83
buffer_store_dwordx4 v[40:43], v18, s[64:67], s72 offen offset:768 sc1
s_branch K1_GDONE
K1_EPI1A:
s_add_u32 s72, s28, 0
s_lshl_b32 s72, s72, 8
v_cvt_pk_bf16_f32 v36, v62, v78
v_cvt_pk_bf16_f32 v37, v66, v82
v_cvt_pk_bf16_f32 v38, v70, v86
v_cvt_pk_bf16_f32 v39, v74, v90
buffer_store_dwordx4 v[36:39], v18, s[64:67], s72 offen offset:0 sc1
v_cvt_pk_bf16_f32 v40, v63, v79
v_cvt_pk_bf16_f32 v41, v67, v83
v_cvt_pk_bf16_f32 v42, v71, v87
v_cvt_pk_bf16_f32 v43, v75, v91
buffer_store_dwordx4 v[40:43], v18, s[64:67], s72 offen offset:256 sc1
v_cvt_pk_bf16_f32 v44, v64, v80
v_cvt_pk_bf16_f32 v45, v68, v84
v_cvt_pk_bf16_f32 v46, v72, v88
v_cvt_pk_bf16_f32 v47, v76, v92
buffer_store_dwordx4 v[44:47], v18, s[64:67], s72 offen offset:512 sc1
v_cvt_pk_bf16_f32 v48, v65, v81
v_cvt_pk_bf16_f32 v49, v69, v85
v_cvt_pk_bf16_f32 v50, v73, v89
v_cvt_pk_bf16_f32 v51, v77, v93
buffer_store_dwordx4 v[48:51], v18, s[64:67], s72 offen offset:768 sc1
s_add_u32 s72, s28, 16
s_lshl_b32 s72, s72, 8
v_cvt_pk_bf16_f32 v52, v94, v110
v_cvt_pk_bf16_f32 v53, v98, v114
v_cvt_pk_bf16_f32 v54, v102, v118
v_cvt_pk_bf16_f32 v55, v106, v122
buffer_store_dwordx4 v[52:55], v18, s[64:67], s72 offen offset:0 sc1
v_cvt_pk_bf16_f32 v56, v95, v111
v_cvt_pk_bf16_f32 v57, v99, v115
v_cvt_pk_bf16_f32 v58, v103, v119
v_cvt_pk_bf16_f32 v59, v107, v123
buffer_store_dwordx4 v[56:59], v18, s[64:67], s72 offen offset:256 sc1
v_cvt_pk_bf16_f32 v36, v96, v112
v_cvt_pk_bf16_f32 v37, v100, v116
v_cvt_pk_bf16_f32 v38, v104, v120
v_cvt_pk_bf16_f32 v39, v108, v124
buffer_store_dwordx4 v[36:39], v18, s[64:67], s72 offen offset:512 sc1
v_cvt_pk_bf16_f32 v40, v97, v113
v_cvt_pk_bf16_f32 v41, v101, v117
v_cvt_pk_bf16_f32 v42, v105, v121
v_cvt_pk_bf16_f32 v43, v109, v125
buffer_store_dwordx4 v[40:43], v18, s[64:67], s72 offen offset:768 sc1
s_branch K1_GDONE
K1_G1:
v_pk_mov_b32 v[62:63], 0, 0
v_pk_mov_b32 v[64:65], 0, 0
v_pk_mov_b32 v[66:67], 0, 0
v_pk_mov_b32 v[68:69], 0, 0
v_pk_mov_b32 v[70:71], 0, 0
v_pk_mov_b32 v[72:73], 0, 0
v_pk_mov_b32 v[74:75], 0, 0
v_pk_mov_b32 v[76:77], 0, 0
v_pk_mov_b32 v[78:79], 0, 0
v_pk_mov_b32 v[80:81], 0, 0
v_pk_mov_b32 v[82:83], 0, 0
v_pk_mov_b32 v[84:85], 0, 0
v_pk_mov_b32 v[86:87], 0, 0
v_pk_mov_b32 v[88:89], 0, 0
v_pk_mov_b32 v[90:91], 0, 0
v_pk_mov_b32 v[92:93], 0, 0
s_mov_b32 s30, 0
s_lshl_b32 s31, s28, 9
K1_QB:
s_waitcnt vmcnt(0)
ds_read_b128 v[20:23], v12 offset:0
ds_read_b128 v[24:27], v13 offset:0
ds_read_b64_tr_b16 v[36:37], v14 offset:0
ds_read_b64_tr_b16 v[38:39], v14 offset:2048
ds_read_b64_tr_b16 v[40:41], v15 offset:0
ds_read_b64_tr_b16 v[42:43], v15 offset:2048
ds_read_b64_tr_b16 v[44:45], v16 offset:0
ds_read_b64_tr_b16 v[46:47], v16 offset:2048
ds_read_b64_tr_b16 v[48:49], v17 offset:0
ds_read_b64_tr_b16 v[50:51], v17 offset:2048
ds_read_b64_tr_b16 v[52:53], v14 offset:32768
ds_read_b64_tr_b16 v[54:55], v14 offset:34816
s_add_u32 s31, s31, 128
s_cmp_eq_u32 s30, 3
s_waitcnt lgkmcnt(10)
s_cbranch_scc1 K1_QXB
s_add_u32 s72, s31, 0
s_add_u32 m0, s29, 0
s_nop 0
buffer_load_dwordx4 v10, s[32:35], s72 offen lds
s_add_u32 m0, s29, 1024
s_nop 0
buffer_load_dwordx4 v11, s[32:35], s72 offen lds
K1_QXB:
s_waitcnt lgkmcnt(8)
v_mfma_f32_16x16x32_bf16 v[62:65], v[20:23], v[36:39], v[62:65]
ds_read_b64_tr_b16 v[56:57], v15 offset:32768
ds_read_b64_tr_b16 v[58:59], v15 offset:34816
s_waitcnt lgkmcnt(8)
v_mfma_f32_16x16x32_bf16 v[66:69], v[20:23], v[40:43], v[66:69]
ds_read_b64_tr_b16 v[36:37], v16 offset:32768
ds_read_b64_tr_b16 v[38:39], v16 offset:34816
s_waitcnt lgkmcnt(8)
v_mfma_f32_16x16x32_bf16 v[70:73], v[20:23], v[44:47], v[70:73]
ds_read_b64_tr_b16 v[40:41], v17 offset:32768
ds_read_b64_tr_b16 v[42:43], v17 offset:34816
s_waitcnt lgkmcnt(8)
v_mfma_f32_16x16x32_bf16 v[74:77], v[20:23], v[48:51], v[74:77]
ds_read_b64_tr_b16 v[44:45], v14 offset:4096
ds_read_b64_tr_b16 v[46:47], v14 offset:6144
s_waitcnt lgkmcnt(8)
v_mfma_f32_16x16x32_bf16 v[78:81], v[20:23], v[52:55], v[78:81]
ds_read_b64_tr_b16 v[48:49], v15 offset:4096
ds_read_b64_tr_b16 v[50:51], v15 offset:6144
s_waitcnt lgkmcnt(8)
v_mfma_f32_16x16x32_bf16 v[82:85], v[20:23], v[56:59], v[82:85]
ds_read_b64_tr_b16 v[52:53], v16 offset:4096
ds_read_b64_tr_b16 v[54:55], v16 offset:6144
s_waitcnt lgkmcnt(8)
v_mfma_f32_16x16x32_bf16 v[86:89], v[20:23], v[36:39], v[86:89]
ds_read_b64_tr_b16 v[56:57], v17 offset:4096
ds_read_b64_tr_b16 v[58:59], v17 offset:6144
s_waitcnt lgkmcnt(8)
v_mfma_f32_16x16x32_bf16 v[90:93], v[20:23], v[40:43], v[90:93]
ds_read_b64_tr_b16 v[36:37], v14 offset:36864
ds_read_b64_tr_b16 v[38:39], v14 offset:38912
s_waitcnt lgkmcnt(8)
v_mfma_f32_16x16x32_bf16 v[62:65], v[24:27], v[44:47], v[62:65]
ds_read_b64_tr_b16 v[40:41], v15 offset:36864
ds_read_b64_tr_b16 v[42:43], v15 offset:38912
s_waitcnt lgkmcnt(8)
v_mfma_f32_16x16x32_bf16 v[66:69], v[24:27], v[48:51], v[66:69]
ds_read_b64_tr_b16 v[44:45], v16 offset:36864
ds_read_b64_tr_b16 v[46:47], v16 offset:38912
s_waitcnt lgkmcnt(8)
v_mfma_f32_16x16x32_bf16 v[70:73], v[24:27], v[52:55], v[70:73]
ds_read_b64_tr_b16 v[48:49], v17 offset:36864
ds_read_b64_tr_b16 v[50:51], v17 offset:38912
s_waitcnt lgkmcnt(8)
v_mfma_f32_16x16x32_bf16 v[74:77], v[24:27], v[56:59], v[74:77]
s_waitcnt lgkmcnt(6)
v_mfma_f32_16x16x32_bf16 v[78:81], v[24:27], v[36:39], v[78:81]
s_waitcnt lgkmcnt(4)
v_mfma_f32_16x16x32_bf16 v[82:85], v[24:27], v[40:43], v[82:85]
s_waitcnt lgkmcnt(2)
v_mfma_f32_16x16x32_bf16 v[86:89], v[24:27], v[44:47], v[86:89]
s_waitcnt lgkmcnt(0)
v_mfma_f32_16x16x32_bf16 v[90:93], v[24:27], v[48:51], v[90:93]
v_add_u32 v14, 8192, v14
v_add_u32 v15, 8192, v15
v_add_u32 v16, 8192, v16
v_add_u32 v17, 8192, v17
s_add_u32 s30, s30, 1
s_cmp_lt_u32 s30, 4
s_cbranch_scc1 K1_QB
s_nop 8
s_cmp_lg_u32 s26, 0
s_cbranch_scc1 K1_EPI1B
s_add_u32 s72, s28, 0
s_lshl_b32 s72, s72, 8
v_mul_f32 v20, s81, v62
v_add_f32 v21, s82, v78
v_cvt_f16_f32 v20, v20
v_add_u32 v21, 0x8000, v21
v_sub_u32 v21, v21, v20
v_perm_b32 v36, v21, v20, s83
v_mul_f32 v22, s81, v66
v_add_f32 v23, s82, v82
v_cvt_f16_f32 v22, v22
v_add_u32 v23, 0x8000, v23
v_sub_u32 v23, v23, v22
v_perm_b32 v37, v23, v22, s83
v_mul_f32 v24, s81, v70
v_add_f32 v25, s82, v86
v_cvt_f16_f32 v24, v24
v_add_u32 v25, 0x8000, v25
v_sub_u32 v25, v25, v24
v_perm_b32 v38, v25, v24, s83
v_mul_f32 v26, s81, v74
v_add_f32 v27, s82, v90
v_cvt_f16_f32 v26, v26
v_add_u32 v27, 0x8000, v27
v_sub_u32 v27, v27, v26
v_perm_b32 v39, v27, v26, s83
buffer_store_dwordx4 v[36:39], v18, s[64:67], s72 offen offset:0 sc1
v_mul_f32 v20, s81, v63
v_add_f32 v21, s82, v79
v_cvt_f16_f32 v20, v20
v_add_u32 v21, 0x8000, v21
v_sub_u32 v21, v21, v20
v_perm_b32 v40, v21, v20, s83
v_mul_f32 v22, s81, v67
v_add_f32 v23, s82, v83
v_cvt_f16_f32 v22, v22
v_add_u32 v23, 0x8000, v23
v_sub_u32 v23, v23, v22
v_perm_b32 v41, v23, v22, s83
v_mul_f32 v24, s81, v71
v_add_f32 v25, s82, v87
v_cvt_f16_f32 v24, v24
v_add_u32 v25, 0x8000, v25
v_sub_u32 v25, v25, v24
v_perm_b32 v42, v25, v24, s83
v_mul_f32 v26, s81, v75
v_add_f32 v27, s82, v91
v_cvt_f16_f32 v26, v26
v_add_u32 v27, 0x8000, v27
v_sub_u32 v27, v27, v26
v_perm_b32 v43, v27, v26, s83
buffer_store_dwordx4 v[40:43], v18, s[64:67], s72 offen offset:256 sc1
v_mul_f32 v20, s81, v64
v_add_f32 v21, s82, v80
v_cvt_f16_f32 v20, v20
v_add_u32 v21, 0x8000, v21
v_sub_u32 v21, v21, v20
v_perm_b32 v44, v21, v20, s83
v_mul_f32 v22, s81, v68
v_add_f32 v23, s82, v84
v_cvt_f16_f32 v22, v22
v_add_u32 v23, 0x8000, v23
v_sub_u32 v23, v23, v22
v_perm_b32 v45, v23, v22, s83
v_mul_f32 v24, s81, v72
v_add_f32 v25, s82, v88
v_cvt_f16_f32 v24, v24
v_add_u32 v25, 0x8000, v25
v_sub_u32 v25, v25, v24
v_perm_b32 v46, v25, v24, s83
v_mul_f32 v26, s81, v76
v_add_f32 v27, s82, v92
v_cvt_f16_f32 v26, v26
v_add_u32 v27, 0x8000, v27
v_sub_u32 v27, v27, v26
v_perm_b32 v47, v27, v26, s83
buffer_store_dwordx4 v[44:47], v18, s[64:67], s72 offen offset:512 sc1
v_mul_f32 v20, s81, v65
v_add_f32 v21, s82, v81
v_cvt_f16_f32 v20, v20
v_add_u32 v21, 0x8000, v21
v_sub_u32 v21, v21, v20
v_perm_b32 v48, v21, v20, s83
v_mul_f32 v22, s81, v69
v_add_f32 v23, s82, v85
v_cvt_f16_f32 v22, v22
v_add_u32 v23, 0x8000, v23
v_sub_u32 v23, v23, v22
v_perm_b32 v49, v23, v22, s83
v_mul_f32 v24, s81, v73
v_add_f32 v25, s82, v89
v_cvt_f16_f32 v24, v24
v_add_u32 v25, 0x8000, v25
v_sub_u32 v25, v25, v24
v_perm_b32 v50, v25, v24, s83
v_mul_f32 v26, s81, v77
v_add_f32 v27, s82, v93
v_cvt_f16_f32 v26, v26
v_add_u32 v27, 0x8000, v27
v_sub_u32 v27, v27, v26
v_perm_b32 v51, v27, v26, s83
buffer_store_dwordx4 v[48:51], v18, s[64:67], s72 offen offset:768 sc1
s_branch K1_GDONE
K1_EPI1B:
s_add_u32 s72, s28, 0
s_lshl_b32 s72, s72, 8
v_cvt_pk_bf16_f32 v36, v62, v78
v_cvt_pk_bf16_f32 v37, v66, v82
v_cvt_pk_bf16_f32 v38, v70, v86
v_cvt_pk_bf16_f32 v39, v74, v90
buffer_store_dwordx4 v[36:39], v18, s[64:67], s72 offen offset:0 sc1
v_cvt_pk_bf16_f32 v40, v63, v79
v_cvt_pk_bf16_f32 v41, v67, v83
v_cvt_pk_bf16_f32 v42, v71, v87
v_cvt_pk_bf16_f32 v43, v75, v91
buffer_store_dwordx4 v[40:43], v18, s[64:67], s72 offen offset:256 sc1
v_cvt_pk_bf16_f32 v44, v64, v80
v_cvt_pk_bf16_f32 v45, v68, v84
v_cvt_pk_bf16_f32 v46, v72, v88
v_cvt_pk_bf16_f32 v47, v76, v92
buffer_store_dwordx4 v[44:47], v18, s[64:67], s72 offen offset:512 sc1
v_cvt_pk_bf16_f32 v48, v65, v81
v_cvt_pk_bf16_f32 v49, v69, v85
v_cvt_pk_bf16_f32 v50, v73, v89
v_cvt_pk_bf16_f32 v51, v77, v93
buffer_store_dwordx4 v[48:51], v18, s[64:67], s72 offen offset:768 sc1
s_branch K1_GDONE
K1_GDONE:
s_setprio 0
s_waitcnt vmcnt(0) lgkmcnt(0)
K1_GDONE2:
s_barrier
s_cmp_lg_u32 s24, 12
s_cbranch_scc1 KF_SIGB
s_lshr_b32 s72, s2, 3
s_lshl_b32 s72, s72, 7
s_and_b32 s73, s2, 7
s_lshl_b32 s73, s73, 2
s_add_u32 s72, s72, s73
s_add_u32 s72, s72, 4096
s_mov_b64 s[94:95], exec
s_mov_b64 exec, 1
v_mov_b32 v121, s84
v_mov_b32 v120, s72
buffer_store_dword v121, v120, s[48:51], 0 offen sc1
s_mov_b64 exec, s[94:95]
KF_SIGB:
v_mov_b32 v4, 131072
ds_read_b32 v9, v4 offset:700
ds_read_b32 v10, v4 offset:720
s_add_u32 s32, s22, 21626880
s_addc_u32 s33, s23, 0
s_and_b32 s33, s33, 0xffff
s_or_b32 s33, s33, 0x200000
s_mov_b32 s34, 163841
s_mov_b32 s35, 0x00020000
s_add_u32 s40, s22, 20971520
s_addc_u32 s41, s23, 0
s_and_b32 s41, s41, 0xffff
s_mov_b32 s42, 655360
s_mov_b32 s43, 0x00020000
v_mov_b32 v11, 0x7ffffff0
v_mov_b32 v13, 1
s_waitcnt lgkmcnt(0)
v_readfirstlane_b32 s72, v9
v_readfirstlane_b32 s91, v10
s_nop 3
s_cmp_lg_u32 s72, 0
s_cbranch_scc1 K2_SLOW
s_cmp_ge_u32 s24, 8
s_cbranch_scc1 K2_MOVER
v_lshl_add_u32 v9, v0, 2, v4
s_cmp_le_u32 s91, 0
s_cbranch_scc1 K2_G_DONE
ds_read_b32 v20, v9 offset:20480
s_cmp_le_u32 s91, 512
s_cbranch_scc1 K2_G_DONE
ds_read_b32 v21, v9 offset:22528
s_cmp_le_u32 s91, 1024
s_cbranch_scc1 K2_G_DONE
ds_read_b32 v22, v9 offset:24576
s_cmp_le_u32 s91, 1536
s_cbranch_scc1 K2_G_DONE
ds_read_b32 v23, v9 offset:26624
s_cmp_le_u32 s91, 2048
s_cbranch_scc1 K2_G_DONE
ds_read_b32 v24, v9 offset:28672
s_cmp_le_u32 s91, 2560
s_cbranch_scc1 K2_G_DONE
ds_read_b32 v25, v9 offset:30720
K2_G_DONE:
s_waitcnt lgkmcnt(0)
s_cmp_le_u32 s91, 0
s_cbranch_scc1 K2_W_DONE
v_add_u32 v12, 0, v0
v_cmp_gt_u32 vcc, s91, v12
v_lshlrev_b32 v12, 2, v20
s_nop 0
v_cndmask_b32_e64 v12, v11, v12, vcc
buffer_load_dword v26, v12, s[40:43], 0 offen
s_cmp_le_u32 s91, 512
s_cbranch_scc1 K2_W_DONE
v_add_u32 v12, 512, v0
v_cmp_gt_u32 vcc, s91, v12
v_lshlrev_b32 v12, 2, v21
s_nop 0
v_cndmask_b32_e64 v12, v11, v12, vcc
buffer_load_dword v27, v12, s[40:43], 0 offen
s_cmp_le_u32 s91, 1024
s_cbranch_scc1 K2_W_DONE
v_add_u32 v12, 1024, v0
v_cmp_gt_u32 vcc, s91, v12
v_lshlrev_b32 v12, 2, v22
s_nop 0
v_cndmask_b32_e64 v12, v11, v12, vcc
buffer_load_dword v28, v12, s[40:43], 0 offen
s_cmp_le_u32 s91, 1536
s_cbranch_scc1 K2_W_DONE
v_add_u32 v12, 1536, v0
v_cmp_gt_u32 vcc, s91, v12
v_lshlrev_b32 v12, 2, v23
s_nop 0
v_cndmask_b32_e64 v12, v11, v12, vcc
buffer_load_dword v29, v12, s[40:43], 0 offen
s_cmp_le_u32 s91, 2048
s_cbranch_scc1 K2_W_DONE
v_add_u32 v12, 2048, v0
v_cmp_gt_u32 vcc, s91, v12
v_lshlrev_b32 v12, 2, v24
s_nop 0
v_cndmask_b32_e64 v12, v11, v12, vcc
buffer_load_dword v30, v12, s[40:43], 0 offen
s_cmp_le_u32 s91, 2560
s_cbranch_scc1 K2_W_DONE
v_add_u32 v12, 2560, v0
v_cmp_gt_u32 vcc, s91, v12
v_lshlrev_b32 v12, 2, v25
s_nop 0
v_cndmask_b32_e64 v12, v11, v12, vcc
buffer_load_dword v31, v12, s[40:43], 0 offen
K2_W_DONE:
s_waitcnt vmcnt(0)
s_cmp_le_u32 s91, 0
s_cbranch_scc1 K2_A_DONE
v_add_u32 v10, 0, v0
v_cmp_gt_u32 vcc, s91, v10
v_lshrrev_b32 v10, 16, v26
v_lshl_add_u32 v10, v10, 2, v4
s_and_saveexec_b64 s[94:95], vcc
ds_add_rtn_u32 v32, v10, v13 offset:0
s_mov_b64 exec, s[94:95]
s_cmp_le_u32 s91, 512
s_cbranch_scc1 K2_A_DONE
v_add_u32 v10, 512, v0
v_cmp_gt_u32 vcc, s91, v10
v_lshrrev_b32 v10, 16, v27
v_lshl_add_u32 v10, v10, 2, v4
s_and_saveexec_b64 s[94:95], vcc
ds_add_rtn_u32 v33, v10, v13 offset:0
s_mov_b64 exec, s[94:95]
s_cmp_le_u32 s91, 1024
s_cbranch_scc1 K2_A_DONE
v_add_u32 v10, 1024, v0
v_cmp_gt_u32 vcc, s91, v10
v_lshrrev_b32 v10, 16, v28
v_lshl_add_u32 v10, v10, 2, v4
s_and_saveexec_b64 s[94:95], vcc
ds_add_rtn_u32 v34, v10, v13 offset:0
s_mov_b64 exec, s[94:95]
s_cmp_le_u32 s91, 1536
s_cbranch_scc1 K2_A_DONE
v_add_u32 v10, 1536, v0
v_cmp_gt_u32 vcc, s91, v10
v_lshrrev_b32 v10, 16, v29
v_lshl_add_u32 v10, v10, 2, v4
s_and_saveexec_b64 s[94:95], vcc
ds_add_rtn_u32 v35, v10, v13 offset:0
s_mov_b64 exec, s[94:95]
s_cmp_le_u32 s91, 2048
s_cbranch_scc1 K2_A_DONE
v_add_u32 v10, 2048, v0
v_cmp_gt_u32 vcc, s91, v10
v_lshrrev_b32 v10, 16, v30
v_lshl_add_u32 v10, v10, 2, v4
s_and_saveexec_b64 s[94:95], vcc
ds_add_rtn_u32 v36, v10, v13 offset:0
s_mov_b64 exec, s[94:95]
s_cmp_le_u32 s91, 2560
s_cbranch_scc1 K2_A_DONE
v_add_u32 v10, 2560, v0
v_cmp_gt_u32 vcc, s91, v10
v_lshrrev_b32 v10, 16, v31
v_lshl_add_u32 v10, v10, 2, v4
s_and_saveexec_b64 s[94:95], vcc
ds_add_rtn_u32 v37, v10, v13 offset:0
s_mov_b64 exec, s[94:95]
K2_A_DONE:
s_waitcnt lgkmcnt(0)
s_branch K2_B1
K2_MOVER:
v_subrev_u32 v16, 512, v0
v_lshrrev_b32 v16, 1, v16
v_lshl_add_u32 v10, v16, 2, v4
s_cmp_le_u32 s91, 0
s_cbranch_scc1 K2_GE_DONE
ds_read_b32 v20, v10 offset:20480
s_cmp_le_u32 s91, 256
s_cbranch_scc1 K2_GE_DONE
ds_read_b32 v21, v10 offset:21504
s_cmp_le_u32 s91, 512
s_cbranch_scc1 K2_GE_DONE
ds_read_b32 v22, v10 offset:22528
s_cmp_le_u32 s91, 768
s_cbranch_scc1 K2_GE_DONE
ds_read_b32 v23, v10 offset:23552
s_cmp_le_u32 s91, 1024
s_cbranch_scc1 K2_GE_DONE
ds_read_b32 v24, v10 offset:24576
s_cmp_le_u32 s91, 1280
s_cbranch_scc1 K2_GE_DONE
ds_read_b32 v25, v10 offset:25600
s_cmp_le_u32 s91, 1536
s_cbranch_scc1 K2_GE_DONE
ds_read_b32 v26, v10 offset:26624
s_cmp_le_u32 s91, 1792
s_cbranch_scc1 K2_GE_DONE
ds_read_b32 v27, v10 offset:27648
s_cmp_le_u32 s91, 2048
s_cbranch_scc1 K2_GE_DONE
ds_read_b32 v28, v10 offset:28672
s_cmp_le_u32 s91, 2304
s_cbranch_scc1 K2_GE_DONE
ds_read_b32 v29, v10 offset:29696
s_cmp_le_u32 s91, 2560
s_cbranch_scc1 K2_GE_DONE
ds_read_b32 v30, v10 offset:30720
K2_GE_DONE:
v_and_b32 v15, 1, v0
v_lshlrev_b32 v15, 4, v15
s_sub_u32 s75, s24, 8
s_lshl_b32 s69, s75, 5
s_lshl_b32 s70, s75, 10
s_add_u32 s70, s70, 40960
s_waitcnt lgkmcnt(0)
s_add_u32 s71, s69, 0
s_cmp_le_u32 s91, s71
s_cbranch_scc1 K2_ED0_DONE
v_add_u32 v17, 0, v16
v_cmp_gt_u32 vcc, s91, v17
s_add_u32 m0, s70, 0
s_nop 0
v_cndmask_b32_e64 v14, v11, v20, vcc
buffer_load_dwordx4 v[14:15], s[32:35], 0 idxen offen lds
s_add_u32 s71, s69, 256
s_cmp_le_u32 s91, s71
s_cbranch_scc1 K2_ED0_DONE
v_add_u32 v17, 256, v16
v_cmp_gt_u32 vcc, s91, v17
s_add_u32 m0, s70, 8192
s_nop 0
v_cndmask_b32_e64 v14, v11, v21, vcc
buffer_load_dwordx4 v[14:15], s[32:35], 0 idxen offen lds
s_add_u32 s71, s69, 512
s_cmp_le_u32 s91, s71
s_cbranch_scc1 K2_ED0_DONE
v_add_u32 v17, 512, v16
v_cmp_gt_u32 vcc, s91, v17
s_add_u32 m0, s70, 16384
s_nop 0
v_cndmask_b32_e64 v14, v11, v22, vcc
buffer_load_dwordx4 v[14:15], s[32:35], 0 idxen offen lds
s_add_u32 s71, s69, 768
s_cmp_le_u32 s91, s71
s_cbranch_scc1 K2_ED0_DONE
v_add_u32 v17, 768, v16
v_cmp_gt_u32 vcc, s91, v17
s_add_u32 m0, s70, 24576
s_nop 0
v_cndmask_b32_e64 v14, v11, v23, vcc
buffer_load_dwordx4 v[14:15], s[32:35], 0 idxen offen lds
s_add_u32 s71, s69, 1024
s_cmp_le_u32 s91, s71
s_cbranch_scc1 K2_ED0_DONE
v_add_u32 v17, 1024, v16
v_cmp_gt_u32 vcc, s91, v17
s_add_u32 m0, s70, 32768
s_nop 0
v_cndmask_b32_e64 v14, v11, v24, vcc
buffer_load_dwordx4 v[14:15], s[32:35], 0 idxen offen lds
s_add_u32 s71, s69, 1280
s_cmp_le_u32 s91, s71
s_cbranch_scc1 K2_ED0_DONE
v_add_u32 v17, 1280, v16
v_cmp_gt_u32 vcc, s91, v17
s_add_u32 m0, s70, 40960
s_nop 0
v_cndmask_b32_e64 v14, v11, v25, vcc
buffer_load_dwordx4 v[14:15], s[32:35], 0 idxen offen lds
s_add_u32 s71, s69, 1536
s_cmp_le_u32 s91, s71
s_cbranch_scc1 K2_ED0_DONE
v_add_u32 v17, 1536, v16
v_cmp_gt_u32 vcc, s91, v17
s_add_u32 m0, s70, 49152
s_nop 0
v_cndmask_b32_e64 v14, v11, v26, vcc
buffer_load_dwordx4 v[14:15], s[32:35], 0 idxen offen lds
s_add_u32 s71, s69, 1792
s_cmp_le_u32 s91, s71
s_cbranch_scc1 K2_ED0_DONE
v_add_u32 v17, 1792, v16
v_cmp_gt_u32 vcc, s91, v17
s_add_u32 m0, s70, 57344
s_nop 0
v_cndmask_b32_e64 v14, v11, v27, vcc
buffer_load_dwordx4 v[14:15], s[32:35], 0 idxen offen lds
s_add_u32 s71, s69, 2048
s_cmp_le_u32 s91, s71
s_cbranch_scc1 K2_ED0_DONE
v_add_u32 v17, 2048, v16
v_cmp_gt_u32 vcc, s91, v17
s_add_u32 m0, s70, 65536
s_nop 0
v_cndmask_b32_e64 v14, v11, v28, vcc
buffer_load_dwordx4 v[14:15], s[32:35], 0 idxen offen lds
s_add_u32 s71, s69, 2304
s_cmp_le_u32 s91, s71
s_cbranch_scc1 K2_ED0_DONE
v_add_u32 v17, 2304, v16
v_cmp_gt_u32 vcc, s91, v17
s_add_u32 m0, s70, 73728
s_nop 0
v_cndmask_b32_e64 v14, v11, v29, vcc
buffer_load_dwordx4 v[14:15], s[32:35], 0 idxen offen lds
s_add_u32 s71, s69, 2560
s_cmp_le_u32 s91, s71
s_cbranch_scc1 K2_ED0_DONE
v_add_u32 v17, 2560, v16
v_cmp_gt_u32 vcc, s91, v17
s_add_u32 m0, s70, 81920
s_nop 0
v_cndmask_b32_e64 v14, v11, v30, vcc
buffer_load_dwordx4 v[14:15], s[32:35], 0 idxen offen lds
K2_ED0_DONE:
s_branch K2_MOVER_WAIT
K2_B1:
s_waitcnt lgkmcnt(0)
v_mov_b32 v120, 163792
v_mov_b32 v121, 1
s_mov_b64 s[94:95], exec
s_mov_b64 exec, 1
ds_add_u32 v120, v121
s_mov_b64 exec, s[94:95]
KQ_SPIN4:
ds_read_b32 v121, v120
s_waitcnt lgkmcnt(0)
v_readfirstlane_b32 s96, v121
s_nop 3
s_cmp_ge_u32 s96, 8
s_cbranch_scc1 KQ_DONE4
s_sleep 1
s_branch KQ_SPIN4
KQ_DONE4:
s_cmp_lg_u32 s24, 0
s_cbranch_scc1 K2_S3_OTHERS
v_lshl_add_u32 v3, v2, 2, v4
ds_read_b32 v92, v3 offset:0
ds_read_b32 v93, v3 offset:256
ds_read_b32 v94, v3 offset:512
s_waitcnt lgkmcnt(0)
v_min_u32 v95, 63, v92
v_sub_u32 v95, 63, v95
v_lshlrev_b32 v95, 2, v95
v_add_u32 v98, v4, v95
v_min_u32 v96, 63, v93
v_sub_u32 v96, 63, v96
v_lshlrev_b32 v96, 2, v96
v_add_u32 v99, v4, v96
v_min_u32 v97, 63, v94
v_sub_u32 v97, 63, v97
v_lshlrev_b32 v97, 2, v97
v_add_u32 v100, v4, v97
ds_add_rtn_u32 v101, v98, v13 offset:1024
ds_add_rtn_u32 v102, v99, v13 offset:1024
s_mov_b32 exec_hi, 0
ds_add_rtn_u32 v103, v100, v13 offset:1024
s_mov_b64 exec, -1
s_waitcnt lgkmcnt(0)
ds_read_b32 v107, v3 offset:1024
s_waitcnt lgkmcnt(0)
v_mov_b32 v108, v107
s_nop 1
v_add_u32_dpp v108, v108, v108 row_shr:1 row_mask:0xf bank_mask:0xf bound_ctrl:0
s_nop 1
v_add_u32_dpp v108, v108, v108 row_shr:2 row_mask:0xf bank_mask:0xf bound_ctrl:0
s_nop 1
v_add_u32_dpp v108, v108, v108 row_shr:4 row_mask:0xf bank_mask:0xf bound_ctrl:0
s_nop 1
v_add_u32_dpp v108, v108, v108 row_shr:8 row_mask:0xf bank_mask:0xf bound_ctrl:0
s_nop 1
v_add_u32_dpp v108, v108, v108 row_bcast:15 row_mask:0xa bank_mask:0xf
s_nop 1
v_add_u32_dpp v108, v108, v108 row_bcast:31 row_mask:0xc bank_mask:0xf
s_nop 1
v_sub_u32 v108, v108, v107
ds_bpermute_b32 v98, v95, v108
ds_bpermute_b32 v99, v96, v108
ds_bpermute_b32 v100, v97, v108
s_waitcnt lgkmcnt(0)
v_add_u32 v98, v98, v101
v_lshl_add_u32 v101, v98, 2, v4
v_add_u32 v104, 0, v2
v_add_u32 v99, v99, v102
v_lshl_add_u32 v102, v99, 2, v4
v_add_u32 v105, 64, v2
v_add_u32 v100, v100, v103
v_lshl_add_u32 v103, v100, 2, v4
v_add_u32 v106, 128, v2
ds_write_b32 v101, v104 offset:1280
ds_write_b32 v101, v92 offset:1920
ds_write_b32 v102, v105 offset:1280
ds_write_b32 v102, v93 offset:1920
s_mov_b32 exec_hi, 0
ds_write_b32 v103, v106 offset:1280
ds_write_b32 v103, v94 offset:1920
s_mov_b64 exec, -1
v_mul_u32_u24 v107, 86, v2
v_lshrrev_b32 v107, 8, v107
v_mul_u32_u24 v108, 3, v107
v_sub_u32 v108, v2, v108
v_subrev_u32 v109, 24, v2
v_lshrrev_b32 v110, 1, v109
v_add_u32 v110, 8, v110
v_and_b32 v109, 1, v109
v_cmp_gt_u32 vcc, 24, v2
s_nop 1
v_cndmask_b32_e64 v107, v110, v107, vcc
v_cndmask_b32_e64 v108, v109, v108, vcc
v_sub_u32 v109, 31, v107
v_add_u32 v110, 32, v107
v_cmp_eq_u32 vcc, 1, v108
s_nop 1
v_cndmask_b32_e64 v109, v107, v109, vcc
v_cmp_eq_u32 vcc, 2, v108
s_nop 1
v_cndmask_b32_e64 v109, v109, v110, vcc
v_min_u32 v109, 39, v109
v_lshl_add_u32 v110, v109, 4, v4
s_waitcnt lgkmcnt(0)
ds_read_b128 v[112:115], v110 offset:1920
s_waitcnt lgkmcnt(0)
v_max_u32 v112, v112, v113
v_max3_u32 v112, v112, v114, v115
v_cmp_gt_u32 vcc, 40, v2
s_nop 1
v_cndmask_b32_e64 v112, 0, v112, vcc
v_add_u32 v113, 3, v112
v_lshrrev_b32 v113, 2, v113
v_mov_b32 v114, v113
s_nop 1
v_add_u32_dpp v114, v114, v114 row_shr:1 row_mask:0xf bank_mask:0xf bound_ctrl:0
s_nop 1
v_add_u32_dpp v114, v114, v114 row_shr:2 row_mask:0xf bank_mask:0xf bound_ctrl:0
s_nop 1
v_add_u32_dpp v114, v114, v114 row_shr:4 row_mask:0xf bank_mask:0xf bound_ctrl:0
s_nop 1
v_add_u32_dpp v114, v114, v114 row_shr:8 row_mask:0xf bank_mask:0xf bound_ctrl:0
s_nop 1
v_add_u32_dpp v114, v114, v114 row_bcast:15 row_mask:0xa bank_mask:0xf
s_nop 1
v_add_u32_dpp v114, v114, v114 row_bcast:31 row_mask:0xc bank_mask:0xf
s_nop 1
v_readlane_b32 s72, v114, 63
v_sub_u32 v114, v114, v113
v_lshl_or_b32 v115, v109, 16, v112
v_lshl_add_u32 v116, v2, 3, v4
v_lshl_add_u32 v117, v109, 2, v4
s_and_saveexec_b64 s[94:95], vcc
ds_write_b64 v116, v[114:115] offset:2816
ds_write_b32 v117, v114 offset:2560
s_mov_b64 exec, s[94:95]
s_cmp_le_u32 s72, 218
s_cbranch_scc1 K2_CAP_OK
ds_write_b32 v4, v13 offset:700
K2_CAP_OK:
s_waitcnt lgkmcnt(0)
v_lshrrev_b32 v101, 2, v98
v_min_u32 v101, 39, v101
v_lshl_add_u32 v101, v101, 2, v4
ds_read_b32 v101, v101 offset:2560
v_lshrrev_b32 v102, 2, v99
v_min_u32 v102, 39, v102
v_lshl_add_u32 v102, v102, 2, v4
ds_read_b32 v102, v102 offset:2560
v_lshrrev_b32 v103, 2, v100
v_min_u32 v103, 39, v103
v_lshl_add_u32 v103, v103, 2, v4
ds_read_b32 v103, v103 offset:2560
s_waitcnt lgkmcnt(0)
v_and_b32 v107, 3, v98
v_lshlrev_b32 v107, 2, v107
v_lshl_add_u32 v101, v101, 4, v107
v_lshl_add_u32 v108, v104, 2, v4
ds_write_b32 v108, v101 offset:3200
v_and_b32 v107, 3, v99
v_lshlrev_b32 v107, 2, v107
v_lshl_add_u32 v102, v102, 4, v107
v_lshl_add_u32 v108, v105, 2, v4
ds_write_b32 v108, v102 offset:3200
v_and_b32 v107, 3, v100
v_lshlrev_b32 v107, 2, v107
v_lshl_add_u32 v103, v103, 4, v107
v_lshl_add_u32 v108, v106, 2, v4
s_mov_b32 exec_hi, 0
ds_write_b32 v108, v103 offset:3200
s_mov_b64 exec, -1
s_waitcnt lgkmcnt(0)
v_mov_b32 v120, 163824
v_mov_b32 v121, 1
s_mov_b64 exec, 1
ds_write_b32 v120, v121
s_mov_b64 exec, -1
K2_S3_OTHERS:
K2_MOVER_WAIT:
v_mov_b32 v120, 163824
K2_B2_SPIN:
ds_read_b32 v121, v120
s_waitcnt lgkmcnt(0)
v_readfirstlane_b32 s96, v121
s_nop 3
s_cmp_lg_u32 s96, 0
s_cbranch_scc1 K2_B2_DONE
s_sleep 1
s_branch K2_B2_SPIN
K2_B2_DONE:
v_lshrrev_b32 v56, 4, v2
v_and_b32 v57, 15, v2
ds_read_b32 v9, v4 offset:700
s_lshl_b32 s73, s89, 3
v_lshl_add_u32 v12, v2, 3, v4
v_add_u32 v12, s73, v12
ds_read_b64 v[18:19], v12 offset:2816
s_cmp_ge_u32 s24, 8
s_cbranch_scc1 K2_SB_DONE
s_cmp_le_u32 s91, 0
s_cbranch_scc1 K2_SB_DONE
v_lshrrev_b32 v12, 16, v26
v_lshl_add_u32 v12, v12, 2, v4
ds_read_b32 v38, v12 offset:3200
s_cmp_le_u32 s91, 512
s_cbranch_scc1 K2_SB_DONE
v_lshrrev_b32 v12, 16, v27
v_lshl_add_u32 v12, v12, 2, v4
ds_read_b32 v39, v12 offset:3200
s_cmp_le_u32 s91, 1024
s_cbranch_scc1 K2_SB_DONE
v_lshrrev_b32 v12, 16, v28
v_lshl_add_u32 v12, v12, 2, v4
ds_read_b32 v40, v12 offset:3200
s_cmp_le_u32 s91, 1536
s_cbranch_scc1 K2_SB_DONE
v_lshrrev_b32 v12, 16, v29
v_lshl_add_u32 v12, v12, 2, v4
ds_read_b32 v41, v12 offset:3200
s_cmp_le_u32 s91, 2048
s_cbranch_scc1 K2_SB_DONE
v_lshrrev_b32 v12, 16, v30
v_lshl_add_u32 v12, v12, 2, v4
ds_read_b32 v42, v12 offset:3200
s_cmp_le_u32 s91, 2560
s_cbranch_scc1 K2_SB_DONE
v_lshrrev_b32 v12, 16, v31
v_lshl_add_u32 v12, v12, 2, v4
ds_read_b32 v43, v12 offset:3200
K2_SB_DONE:
s_waitcnt lgkmcnt(0)
v_readfirstlane_b32 s77, v9
v_readlane_b32 s30, v18, 0
v_readlane_b32 s56, v19, 0
v_readlane_b32 s57, v19, 1
v_readlane_b32 s58, v19, 2
s_nop 3
s_cmp_lg_u32 s77, 0
s_cbranch_scc1 K2_SLOW
s_cmp_ge_u32 s24, 8
s_cbranch_scc1 K2_SC_MOVER
s_cmp_le_u32 s91, 0
s_cbranch_scc1 K2_SC_DONE
v_add_u32 v17, 0, v0
v_cmp_gt_u32 vcc, s91, v17
v_and_b32 v12, 3, v32
v_sub_u32 v10, v32, v12
v_lshl_add_u32 v10, v10, 2, v12
v_add_u32 v10, v10, v38
v_lshl_add_u32 v10, v10, 1, v4
s_and_saveexec_b64 s[94:95], vcc
ds_write_b16 v10, v26 offset:6144
ds_write_b16 v10, v17 offset:13312
s_mov_b64 exec, s[94:95]
s_cmp_le_u32 s91, 512
s_cbranch_scc1 K2_SC_DONE
v_add_u32 v17, 512, v0
v_cmp_gt_u32 vcc, s91, v17
v_and_b32 v12, 3, v33
v_sub_u32 v10, v33, v12
v_lshl_add_u32 v10, v10, 2, v12
v_add_u32 v10, v10, v39
v_lshl_add_u32 v10, v10, 1, v4
s_and_saveexec_b64 s[94:95], vcc
ds_write_b16 v10, v27 offset:6144
ds_write_b16 v10, v17 offset:13312
s_mov_b64 exec, s[94:95]
s_cmp_le_u32 s91, 1024
s_cbranch_scc1 K2_SC_DONE
v_add_u32 v17, 1024, v0
v_cmp_gt_u32 vcc, s91, v17
v_and_b32 v12, 3, v34
v_sub_u32 v10, v34, v12
v_lshl_add_u32 v10, v10, 2, v12
v_add_u32 v10, v10, v40
v_lshl_add_u32 v10, v10, 1, v4
s_and_saveexec_b64 s[94:95], vcc
ds_write_b16 v10, v28 offset:6144
ds_write_b16 v10, v17 offset:13312
s_mov_b64 exec, s[94:95]
s_cmp_le_u32 s91, 1536
s_cbranch_scc1 K2_SC_DONE
v_add_u32 v17, 1536, v0
v_cmp_gt_u32 vcc, s91, v17
v_and_b32 v12, 3, v35
v_sub_u32 v10, v35, v12
v_lshl_add_u32 v10, v10, 2, v12
v_add_u32 v10, v10, v41
v_lshl_add_u32 v10, v10, 1, v4
s_and_saveexec_b64 s[94:95], vcc
ds_write_b16 v10, v29 offset:6144
ds_write_b16 v10, v17 offset:13312
s_mov_b64 exec, s[94:95]
s_cmp_le_u32 s91, 2048
s_cbranch_scc1 K2_SC_DONE
v_add_u32 v17, 2048, v0
v_cmp_gt_u32 vcc, s91, v17
v_and_b32 v12, 3, v36
v_sub_u32 v10, v36, v12
v_lshl_add_u32 v10, v10, 2, v12
v_add_u32 v10, v10, v42
v_lshl_add_u32 v10, v10, 1, v4
s_and_saveexec_b64 s[94:95], vcc
ds_write_b16 v10, v30 offset:6144
ds_write_b16 v10, v17 offset:13312
s_mov_b64 exec, s[94:95]
s_cmp_le_u32 s91, 2560
s_cbranch_scc1 K2_SC_DONE
v_add_u32 v17, 2560, v0
v_cmp_gt_u32 vcc, s91, v17
v_and_b32 v12, 3, v37
v_sub_u32 v10, v37, v12
v_lshl_add_u32 v10, v10, 2, v12
v_add_u32 v10, v10, v43
v_lshl_add_u32 v10, v10, 1, v4
s_and_saveexec_b64 s[94:95], vcc
ds_write_b16 v10, v31 offset:6144
ds_write_b16 v10, v17 offset:13312
s_mov_b64 exec, s[94:95]
K2_SC_DONE:
s_branch K2_SC_ALL
K2_SC_MOVER:
K2_SC_ALL:
s_cmp_lg_u32 s24, 1
s_cbranch_scc1 KF_PB_SKIP
v_mov_b32 v119, 163828
ds_read_b32 v118, v119
s_add_u32 s52, s22, 27988096
s_addc_u32 s53, s23, 0
s_and_b32 s53, s53, 0xffff
s_mov_b32 s54, 4096
s_mov_b32 s55, 0x00020000
v_lshrrev_b32 v119, 1, v2
v_lshlrev_b32 v119, 7, v119
v_and_b32 v117, 1, v2
v_lshl_add_u32 v119, v117, 4, v119
buffer_load_dwordx4 v[112:115], v119, s[52:55], 0 offen
s_mov_b32 s97, 0x4000
s_waitcnt lgkmcnt(0)
v_readfirstlane_b32 s96, v118
s_nop 1
KF_POLLB:
s_waitcnt vmcnt(0)
v_xor_b32 v112, s96, v112
v_xor_b32 v113, s96, v113
v_xor_b32 v114, s96, v114
v_xor_b32 v115, s96, v115
v_or_b32 v112, v112, v113
v_or3_b32 v112, v112, v114, v115
v_cmp_ne_u32 vcc, 0, v112
s_cbranch_vccz KF_POLLDB
s_sub_u32 s97, s97, 1
s_cmp_eq_u32 s97, 0
s_cbranch_scc1 KF_POLLDB
s_sleep 4
buffer_load_dwordx4 v[112:115], v119, s[52:55], 0 offen sc1
s_branch KF_POLLB
KF_POLLDB:
KF_PB_SKIP:
v_mov_b32 v8, 0
v_lshlrev_b32 v9, 2, v0
v_add_u32 v9, 130048, v9
v_cmp_gt_u32 vcc, 8, v0
s_and_saveexec_b64 s[94:95], vcc
s_cbranch_execz K2_Z3
ds_write_b32 v9, v8
K2_Z3:
s_mov_b64 exec, s[94:95]
s_mul_i32 s72, s85, 2621440
s_add_u32 s36, s22, s72
s_addc_u32 s37, s23, 0
s_and_b32 s37, s37, 0xffff
s_or_b32 s37, s37, 0x1000000
s_mov_b32 s38, 10001
s_mov_b32 s39, 0x00020000
s_add_u32 s40, s22, s72
s_addc_u32 s41, s23, 0
s_add_u32 s40, s40, 10485760
s_addc_u32 s41, s41, 0
s_and_b32 s41, s41, 0xffff
s_or_b32 s41, s41, 0x1000000
s_mov_b32 s42, 10000
s_mov_b32 s43, 0x00020000
s_mov_b32 s44, s18
s_mov_b32 s45, s19
s_and_b32 s45, s45, 0xffff
s_or_b32 s45, s45, 0x2000000
s_mov_b32 s46, 10000
s_mov_b32 s47, 0x00020000
s_mov_b32 s62, 0xbfb8aa3b
s_mov_b32 s63, 0xbfb8aa3b
s_movk_i32 s66, 0x3f80
s_mov_b32 s67, 0x5f800000
s_mov_b32 s68, 0xffff0000
s_mov_b64 s[60:61], 0
v_lshl_add_u32 v58, v56, 2, v4
s_lshr_b32 s72, s56, 16
s_min_u32 s72, s72, 39
s_lshl_b32 s72, s72, 4
v_add_u32 v9, s72, v58
ds_read_b32 v60, v9 offset:1280
s_and_b32 s56, s56, 0xffff
s_lshr_b32 s72, s57, 16
s_min_u32 s72, s72, 39
s_lshl_b32 s72, s72, 4
v_add_u32 v9, s72, v58
ds_read_b32 v61, v9 offset:1280
s_and_b32 s57, s57, 0xffff
s_lshr_b32 s72, s58, 16
s_min_u32 s72, s72, 39
s_lshl_b32 s72, s72, 4
v_add_u32 v9, s72, v58
ds_read_b32 v62, v9 offset:1280
s_and_b32 s58, s58, 0xffff
s_cmp_eq_u32 s90, 2
s_cselect_b32 s58, 0, s58
s_mov_b32 s59, 0
v_mov_b32 v17, 0x7fffffff
s_waitcnt lgkmcnt(0)
v_cmp_gt_u32 vcc, s88, v60
v_add_u32 v60, s87, v60
s_nop 0
v_cndmask_b32_e64 v60, v17, v60, vcc
v_cmp_gt_u32 vcc, s88, v61
v_add_u32 v61, s87, v61
s_nop 0
v_cndmask_b32_e64 v61, v17, v61, vcc
v_cmp_gt_u32 vcc, s88, v62
v_add_u32 v62, s87, v62
s_nop 0
v_cndmask_b32_e64 v62, v17, v62, vcc
v_lshrrev_b32 v7, 2, v57
v_lshl_add_u32 v7, v56, 2, v7
v_lshl_add_u32 v7, v7, 7, v4
v_and_b32 v5, 3, v57
v_lshl_add_u32 v7, v5, 3, v7
s_lshl_b32 s72, s30, 5
s_add_u32 s72, s72, 131072
v_lshlrev_b32 v122, 3, v56
v_add_u32 v122, s72, v122
v_lshlrev_b32 v123, 1, v57
v_add_u32 v123, s72, v123
ds_read_b64_tr_b16 v[8:9], v7 offset:4096
ds_read_b64_tr_b16 v[10:11], v7 offset:4128
ds_read_b64_tr_b16 v[12:13], v7 offset:4160
ds_read_b64_tr_b16 v[14:15], v7 offset:4192
v_lshlrev_b32 v124, 3, v56
v_add_u32 v124, 40960, v124
s_lshl_b32 s73, s89, 10
v_lshlrev_b32 v125, 4, v2
v_add_u32 v125, s73, v125
v_lshlrev_b32 v5, 7, v56
v_add_u32 v5, s73, v5
v_lshl_add_u32 v6, v57, 3, v5
v_lshl_add_u32 v5, v57, 1, v5
v_lshlrev_b32 v49, 4, v57
v_lshlrev_b32 v51, 4, v57
v_lshlrev_b32 v53, 4, v57
v_lshlrev_b32 v55, 4, v57
s_waitcnt vmcnt(0) lgkmcnt(0)
s_barrier
s_setprio 3
ds_read_u16 v48, v122 offset:6144
ds_read_u16 v50, v122 offset:6146
ds_read_u16 v52, v122 offset:6148
ds_read_u16 v54, v122 offset:6150
ds_read_u16 v58, v123 offset:13312
v_lshlrev_b32 v121, 4, v57
s_lshl_b32 s73, s89, 10
v_mov_b32 v120, v60
s_add_u32 m0, s73, 0
s_nop 0
buffer_load_dwordx4 v[120:121], s[40:43], 0 idxen offen lds
s_waitcnt lgkmcnt(0)
buffer_load_dwordx4 v[64:67], v[48:49], s[36:39], 0 idxen offen
buffer_load_dwordx4 v[68:71], v[50:51], s[36:39], 0 idxen offen
buffer_load_dwordx4 v[72:75], v[52:53], s[36:39], 0 idxen offen
buffer_load_dwordx4 v[76:79], v[54:55], s[36:39], 0 idxen offen
v_mov_b32 v120, v61
s_add_u32 m0, s73, 1024
s_nop 0
buffer_load_dwordx4 v[120:121], s[40:43], 0 idxen offen lds
v_mov_b32 v120, v62
s_movk_i32 s75, 1024
s_cmp_eq_u32 s90, 3
s_cselect_b32 s74, 2048, s75
s_cbranch_scc1 K2_T2_3
v_mov_b32 v120, v61
K2_T2_3:
s_add_u32 m0, s73, s74
s_nop 0
buffer_load_dwordx4 v[120:121], s[40:43], 0 idxen offen lds
v_lshl_add_u32 v59, v58, 5, v124
ds_read_b64 v[96:97], v59
ds_read_u16 v48, v122 offset:6176
ds_read_u16 v50, v122 offset:6178
ds_read_u16 v52, v122 offset:6180
ds_read_u16 v54, v122 offset:6182
ds_read_u16 v58, v123 offset:13344
s_lshl_b32 s72, s85, 7
v_lshlrev_b32 v121, 3, v57
v_add_u32 v121, s72, v121
s_mov_b32 s65, 0
s_waitcnt vmcnt(6)
s_call_b64 s[92:93], K2_GSTART
s_cmp_eq_u32 s64, 0
s_cbranch_scc1 K2_TAIL0
.p2align 3
K2_BODY0:
s_waitcnt lgkmcnt(0)
v_mfma_f32_16x16x16_bf16 v[32:35], v[96:97], v[8:9], v[16:19]
v_mfma_f32_16x16x16_bf16 v[36:39], v[96:97], v[10:11], v[20:23]
v_mfma_f32_16x16x16_bf16 v[40:43], v[96:97], v[12:13], v[24:27]
v_mfma_f32_16x16x16_bf16 v[44:47], v[96:97], v[14:15], v[28:31]
buffer_load_dwordx4 v[80:83], v[48:49], s[36:39], 0 idxen offen
buffer_load_dwordx4 v[84:87], v[50:51], s[36:39], 0 idxen offen
buffer_load_dwordx4 v[88:91], v[52:53], s[36:39], 0 idxen offen
buffer_load_dwordx4 v[92:95], v[54:55], s[36:39], 0 idxen offen
v_lshl_add_u32 v59, v58, 5, v124
ds_read_b64 v[98:99], v59
ds_read_u16 v48, v122 offset:6208
ds_read_u16 v50, v122 offset:6210
ds_read_u16 v52, v122 offset:6212
ds_read_u16 v54, v122 offset:6214
ds_read_u16 v58, v123 offset:13376
s_waitcnt vmcnt(4)
v_fma_mix_f32 v112, v32, s81, v64 op_sel_hi:[0,0,1]
v_fma_mix_f32 v113, v36, s81, v65 op_sel_hi:[0,0,1]
v_fma_mix_f32 v114, v40, s81, v66 op_sel_hi:[0,0,1]
v_fma_mix_f32 v115, v44, s81, v67 op_sel_hi:[0,0,1]
v_exp_f32 v112, v112
v_exp_f32 v113, v113
v_exp_f32 v114, v114
v_exp_f32 v115, v115
s_cmp_eq_u32 s64, 1
v_pk_fma_f32 v[108:109], v[100:101], v[112:113], v[100:101]
v_pk_fma_f32 v[110:111], v[102:103], v[114:115], v[102:103]
v_pk_fma_f32 v[100:101], v[64:65], v[104:105], v[108:109]
v_pk_fma_f32 v[102:103], v[66:67], v[106:107], v[110:111]
v_pk_fma_f32 v[104:105], v[104:105], v[112:113], v[104:105]
v_pk_fma_f32 v[106:107], v[106:107], v[114:115], v[106:107]
s_cbranch_scc1 K2_FIN0
v_fma_mix_f32 v112, v33, s81, v68 op_sel_hi:[0,0,1]
v_fma_mix_f32 v113, v37, s81, v69 op_sel_hi:[0,0,1]
v_fma_mix_f32 v114, v41, s81, v70 op_sel_hi:[0,0,1]
v_fma_mix_f32 v115, v45, s81, v71 op_sel_hi:[0,0,1]
v_exp_f32 v112, v112
v_exp_f32 v113, v113
v_exp_f32 v114, v114
v_exp_f32 v115, v115
s_cmp_eq_u32 s64, 2
v_pk_fma_f32 v[108:109], v[100:101], v[112:113], v[100:101]
v_pk_fma_f32 v[110:111], v[102:103], v[114:115], v[102:103]
v_pk_fma_f32 v[100:101], v[68:69], v[104:105], v[108:109]
v_pk_fma_f32 v[102:103], v[70:71], v[106:107], v[110:111]
v_pk_fma_f32 v[104:105], v[104:105], v[112:113], v[104:105]
v_pk_fma_f32 v[106:107], v[106:107], v[114:115], v[106:107]
s_cbranch_scc1 K2_FIN0
v_fma_mix_f32 v112, v34, s81, v72 op_sel_hi:[0,0,1]
v_fma_mix_f32 v113, v38, s81, v73 op_sel_hi:[0,0,1]
v_fma_mix_f32 v114, v42, s81, v74 op_sel_hi:[0,0,1]
v_fma_mix_f32 v115, v46, s81, v75 op_sel_hi:[0,0,1]
v_exp_f32 v112, v112
v_exp_f32 v113, v113
v_exp_f32 v114, v114
v_exp_f32 v115, v115
s_cmp_eq_u32 s64, 3
v_pk_fma_f32 v[108:109], v[100:101], v[112:113], v[100:101]
v_pk_fma_f32 v[110:111], v[102:103], v[114:115], v[102:103]
v_pk_fma_f32 v[100:101], v[72:73], v[104:105], v[108:109]
v_pk_fma_f32 v[102:103], v[74:75], v[106:107], v[110:111]
v_pk_fma_f32 v[104:105], v[104:105], v[112:113], v[104:105]
v_pk_fma_f32 v[106:107], v[106:107], v[114:115], v[106:107]
s_cbranch_scc1 K2_FIN0
v_fma_mix_f32 v112, v35, s81, v76 op_sel_hi:[0,0,1]
v_fma_mix_f32 v113, v39, s81, v77 op_sel_hi:[0,0,1]
v_fma_mix_f32 v114, v43, s81, v78 op_sel_hi:[0,0,1]
v_fma_mix_f32 v115, v47, s81, v79 op_sel_hi:[0,0,1]
v_exp_f32 v112, v112
v_exp_f32 v113, v113
v_exp_f32 v114, v114
v_exp_f32 v115, v115
s_cmp_eq_u32 s64, 4
v_pk_fma_f32 v[108:109], v[100:101], v[112:113], v[100:101]
v_pk_fma_f32 v[110:111], v[102:103], v[114:115], v[102:103]
v_pk_fma_f32 v[100:101], v[76:77], v[104:105], v[108:109]
v_pk_fma_f32 v[102:103], v[78:79], v[106:107], v[110:111]
v_pk_fma_f32 v[104:105], v[104:105], v[112:113], v[104:105]
v_pk_fma_f32 v[106:107], v[106:107], v[114:115], v[106:107]
s_cbranch_scc1 K2_FIN0
s_sub_u32 s64, s64, 4
K2_NEXT0:
K2_BODY1:
s_waitcnt lgkmcnt(0)
v_mfma_f32_16x16x16_bf16 v[32:35], v[98:99], v[8:9], v[16:19]
v_mfma_f32_16x16x16_bf16 v[36:39], v[98:99], v[10:11], v[20:23]
v_mfma_f32_16x16x16_bf16 v[40:43], v[98:99], v[12:13], v[24:27]
v_mfma_f32_16x16x16_bf16 v[44:47], v[98:99], v[14:15], v[28:31]
buffer_load_dwordx4 v[64:67], v[48:49], s[36:39], 0 idxen offen
buffer_load_dwordx4 v[68:71], v[50:51], s[36:39], 0 idxen offen
buffer_load_dwordx4 v[72:75], v[52:53], s[36:39], 0 idxen offen
buffer_load_dwordx4 v[76:79], v[54:55], s[36:39], 0 idxen offen
v_lshl_add_u32 v59, v58, 5, v124
ds_read_b64 v[96:97], v59
ds_read_u16 v48, v122 offset:6240
ds_read_u16 v50, v122 offset:6242
ds_read_u16 v52, v122 offset:6244
ds_read_u16 v54, v122 offset:6246
ds_read_u16 v58, v123 offset:13408
s_waitcnt vmcnt(4)
v_fma_mix_f32 v112, v32, s81, v80 op_sel_hi:[0,0,1]
v_fma_mix_f32 v113, v36, s81, v81 op_sel_hi:[0,0,1]
v_fma_mix_f32 v114, v40, s81, v82 op_sel_hi:[0,0,1]
v_fma_mix_f32 v115, v44, s81, v83 op_sel_hi:[0,0,1]
v_exp_f32 v112, v112
v_exp_f32 v113, v113
v_exp_f32 v114, v114
v_exp_f32 v115, v115
s_cmp_eq_u32 s64, 1
v_pk_fma_f32 v[108:109], v[100:101], v[112:113], v[100:101]
v_pk_fma_f32 v[110:111], v[102:103], v[114:115], v[102:103]
v_pk_fma_f32 v[100:101], v[80:81], v[104:105], v[108:109]
v_pk_fma_f32 v[102:103], v[82:83], v[106:107], v[110:111]
v_pk_fma_f32 v[104:105], v[104:105], v[112:113], v[104:105]
v_pk_fma_f32 v[106:107], v[106:107], v[114:115], v[106:107]
s_cbranch_scc1 K2_FIN1
v_fma_mix_f32 v112, v33, s81, v84 op_sel_hi:[0,0,1]
v_fma_mix_f32 v113, v37, s81, v85 op_sel_hi:[0,0,1]
v_fma_mix_f32 v114, v41, s81, v86 op_sel_hi:[0,0,1]
v_fma_mix_f32 v115, v45, s81, v87 op_sel_hi:[0,0,1]
v_exp_f32 v112, v112
v_exp_f32 v113, v113
v_exp_f32 v114, v114
v_exp_f32 v115, v115
s_cmp_eq_u32 s64, 2
v_pk_fma_f32 v[108:109], v[100:101], v[112:113], v[100:101]
v_pk_fma_f32 v[110:111], v[102:103], v[114:115], v[102:103]
v_pk_fma_f32 v[100:101], v[84:85], v[104:105], v[108:109]
v_pk_fma_f32 v[102:103], v[86:87], v[106:107], v[110:111]
v_pk_fma_f32 v[104:105], v[104:105], v[112:113], v[104:105]
v_pk_fma_f32 v[106:107], v[106:107], v[114:115], v[106:107]
s_cbranch_scc1 K2_FIN1
v_fma_mix_f32 v112, v34, s81, v88 op_sel_hi:[0,0,1]
v_fma_mix_f32 v113, v38, s81, v89 op_sel_hi:[0,0,1]
v_fma_mix_f32 v114, v42, s81, v90 op_sel_hi:[0,0,1]
v_fma_mix_f32 v115, v46, s81, v91 op_sel_hi:[0,0,1]
v_exp_f32 v112, v112
v_exp_f32 v113, v113
v_exp_f32 v114, v114
v_exp_f32 v115, v115
s_cmp_eq_u32 s64, 3
v_pk_fma_f32 v[108:109], v[100:101], v[112:113], v[100:101]
v_pk_fma_f32 v[110:111], v[102:103], v[114:115], v[102:103]
v_pk_fma_f32 v[100:101], v[88:89], v[104:105], v[108:109]
v_pk_fma_f32 v[102:103], v[90:91], v[106:107], v[110:111]
v_pk_fma_f32 v[104:105], v[104:105], v[112:113], v[104:105]
v_pk_fma_f32 v[106:107], v[106:107], v[114:115], v[106:107]
s_cbranch_scc1 K2_FIN1
v_fma_mix_f32 v112, v35, s81, v92 op_sel_hi:[0,0,1]
v_fma_mix_f32 v113, v39, s81, v93 op_sel_hi:[0,0,1]
v_fma_mix_f32 v114, v43, s81, v94 op_sel_hi:[0,0,1]
v_fma_mix_f32 v115, v47, s81, v95 op_sel_hi:[0,0,1]
v_exp_f32 v112, v112
v_exp_f32 v113, v113
v_exp_f32 v114, v114
v_exp_f32 v115, v115
s_cmp_eq_u32 s64, 4
v_pk_fma_f32 v[108:109], v[100:101], v[112:113], v[100:101]
v_pk_fma_f32 v[110:111], v[102:103], v[114:115], v[102:103]
v_pk_fma_f32 v[100:101], v[92:93], v[104:105], v[108:109]
v_pk_fma_f32 v[102:103], v[94:95], v[106:107], v[110:111]
v_pk_fma_f32 v[104:105], v[104:105], v[112:113], v[104:105]
v_pk_fma_f32 v[106:107], v[106:107], v[114:115], v[106:107]
s_cbranch_scc1 K2_FIN1
s_sub_u32 s64, s64, 4
K2_NEXT1:
v_add_u32 v122, 64, v122
v_add_u32 v123, 64, v123
s_branch K2_BODY0
K2_FIN0:
s_call_b64 s[92:93], K2_FINALIZE
s_cmp_eq_u32 s64, 0
s_cbranch_scc1 K2_TAIL
s_branch K2_NEXT0
K2_FIN1:
s_call_b64 s[92:93], K2_FINALIZE
s_cmp_eq_u32 s64, 0
s_cbranch_scc1 K2_TAIL
s_branch K2_NEXT1
s_branch K2_TAIL
K2_TAIL0:
s_waitcnt vmcnt(0)
K2_TAIL:
s_cmp_ge_u32 s65, s90
s_cbranch_scc1 K2_MAIN_DONE
s_call_b64 s[92:93], K2_FINALIZE
s_branch K2_TAIL
K2_FINALIZE:
v_rcp_f32 v32, v104
v_rcp_f32 v33, v105
v_rcp_f32 v34, v106
v_rcp_f32 v35, v107
v_max3_f32 v40, v104, v105, v106
v_max_f32 v40, v40, v107
v_cmp_le_f32 vcc, s67, v40
s_or_b64 s[60:61], s[60:61], vcc
v_pk_mul_f32 v[32:33], v[100:101], v[32:33]
v_pk_mul_f32 v[34:35], v[102:103], v[34:35]
v_dot2_f32_bf16 v36, v116, s66, v32
v_dot2_f32_bf16 v37, v117, s66, v33
v_dot2_f32_bf16 v38, v118, s66, v34
v_dot2_f32_bf16 v39, v119, s66, v35
v_pk_add_f32 v[40:41], v[36:37], v[38:39]
v_pk_mul_f32 v[32:33], v[36:37], s[62:63]
v_pk_mul_f32 v[34:35], v[38:39], s[62:63]
v_add_f32 v40, v40, v41
v_exp_f32 v32, v32
v_exp_f32 v33, v33
v_exp_f32 v34, v34
v_exp_f32 v35, v35
v_mov_b32 v41, 0x207
v_cmp_class_f32 vcc, v40, v41
s_or_b64 s[60:61], s[60:61], vcc
v_pk_add_f32 v[32:33], v[32:33], 1.0 op_sel_hi:[1,0]
v_pk_add_f32 v[34:35], v[34:35], 1.0 op_sel_hi:[1,0]
v_rcp_f32 v32, v32
v_rcp_f32 v33, v33
v_rcp_f32 v34, v34
v_rcp_f32 v35, v35
s_add_u32 s65, s65, 1
s_cmp_eq_u32 s65, 1
s_cbranch_scc0 K2_PRIO1
s_setprio 2
s_branch K2_PRIO2
K2_PRIO1:
s_setprio 0
K2_PRIO2:
v_pk_mul_f32 v[36:37], v[36:37], v[32:33]
v_pk_mul_f32 v[38:39], v[38:39], v[34:35]
v_cvt_pk_bf16_f32 v40, v36, v37
v_cvt_pk_bf16_f32 v41, v38, v39
ds_write_b16 v5, v40
ds_write_b16_d16_hi v5, v40 offset:32
ds_write_b16 v5, v41 offset:64
ds_write_b16_d16_hi v5, v41 offset:96
s_waitcnt lgkmcnt(0)
ds_read_b64 v[42:43], v6
v_add_u32 v125, 1024, v125
v_add_u32 v5, 1024, v5
v_add_u32 v6, 1024, v6
s_mov_b32 s56, s57
s_mov_b32 s57, s58
s_mov_b32 s58, s59
v_mov_b32 v60, v61
v_mov_b32 v61, v62
s_waitcnt lgkmcnt(0)
buffer_store_dwordx2 v[42:43], v[120:121], s[44:47], 0 idxen offen sc1
K2_GSTART:
ds_read_b128 v[116:119], v125
s_mov_b32 s64, s56
v_pk_mov_b32 v[100:101], 0, 0
v_pk_mov_b32 v[102:103], 0, 0
v_pk_mov_b32 v[104:105], 1.0, 1.0
v_pk_mov_b32 v[106:107], 1.0, 1.0
v_mov_b32 v120, v60
s_waitcnt lgkmcnt(0)
v_and_b32 v108, s68, v116
v_and_b32 v109, s68, v117
v_and_b32 v110, s68, v118
v_and_b32 v111, s68, v119
v_pk_mov_b32 v[16:17], v[108:109], v[108:109] op_sel:[0,0]
v_pk_mov_b32 v[18:19], v[108:109], v[108:109] op_sel:[0,0]
v_pk_mov_b32 v[20:21], v[108:109], v[108:109] op_sel:[1,1]
v_pk_mov_b32 v[22:23], v[108:109], v[108:109] op_sel:[1,1]
v_pk_mov_b32 v[24:25], v[110:111], v[110:111] op_sel:[0,0]
v_pk_mov_b32 v[26:27], v[110:111], v[110:111] op_sel:[0,0]
v_pk_mov_b32 v[28:29], v[110:111], v[110:111] op_sel:[1,1]
v_pk_mov_b32 v[30:31], v[110:111], v[110:111] op_sel:[1,1]
s_setpc_b64 s[92:93]
K2_MAIN_DONE:
s_cmp_eq_u64 s[60:61], 0
s_cbranch_scc1 K2_NOFLAG
v_mov_b32 v10, 1
ds_write_b32 v4, v10 offset:700
K2_NOFLAG:
s_waitcnt vmcnt(0) lgkmcnt(0)
s_barrier
ds_read_b32 v9, v4 offset:700
s_waitcnt lgkmcnt(0)
v_readfirstlane_b32 s72, v9
s_nop 3
s_cmp_eq_u32 s72, 0
s_cbranch_scc1 K_END
K2_SLOW:
s_waitcnt vmcnt(0) lgkmcnt(0)
s_cmp_lg_u32 s24, 1
s_cbranch_scc1 KF_PS_SKIP
v_mov_b32 v119, 163828
ds_read_b32 v118, v119
s_add_u32 s52, s22, 27988096
s_addc_u32 s53, s23, 0
s_and_b32 s53, s53, 0xffff
s_mov_b32 s54, 4096
s_mov_b32 s55, 0x00020000
v_lshrrev_b32 v119, 1, v2
v_lshlrev_b32 v119, 7, v119
v_and_b32 v117, 1, v2
v_lshl_add_u32 v119, v117, 4, v119
buffer_load_dwordx4 v[112:115], v119, s[52:55], 0 offen
s_mov_b32 s97, 0x4000
s_waitcnt lgkmcnt(0)
v_readfirstlane_b32 s96, v118
s_nop 1
KF_POLLS:
s_waitcnt vmcnt(0)
v_xor_b32 v112, s96, v112
v_xor_b32 v113, s96, v113
v_xor_b32 v114, s96, v114
v_xor_b32 v115, s96, v115
v_or_b32 v112, v112, v113
v_or3_b32 v112, v112, v114, v115
v_cmp_ne_u32 vcc, 0, v112
s_cbranch_vccz KF_POLLDS
s_sub_u32 s97, s97, 1
s_cmp_eq_u32 s97, 0
s_cbranch_scc1 KF_POLLDS
s_sleep 4
buffer_load_dwordx4 v[112:115], v119, s[52:55], 0 offen sc1
s_branch KF_POLLS
KF_POLLDS:
KF_PS_SKIP:
s_barrier
s_mov_b32 s68, 0xffff0000
v_mov_b32 v12, 0
v_mov_b32 v13, 0
v_mov_b32 v14, 0
v_mov_b32 v15, 0
v_lshlrev_b32 v10, 4, v0
ds_write_b128 v10, v[12:15]
ds_write_b128 v10, v[12:15] offset:16384
v_cmp_gt_u32 vcc, 512, v0
s_and_saveexec_b64 s[94:95], vcc
s_cbranch_execz K2_SLZ
ds_write_b128 v10, v[12:15] offset:32768
K2_SLZ:
s_mov_b64 exec, s[94:95]
s_mov_b32 s32, s10
s_mov_b32 s33, s11
s_and_b32 s33, s33, 0xffff
s_mov_b32 s34, 640000
s_mov_b32 s35, 0x00020000
s_mov_b32 s36, s8
s_mov_b32 s37, s9
s_and_b32 s37, s37, 0xffff
s_mov_b32 s38, 640000
s_mov_b32 s39, 0x00020000
s_mov_b32 s44, s6
s_mov_b32 s45, s7
s_and_b32 s45, s45, 0xffff
s_mov_b32 s46, 5120000
s_mov_b32 s47, 0x00020000
s_mul_i32 s72, s85, 2621440
s_add_u32 s40, s22, s72
s_addc_u32 s41, s23, 0
s_and_b32 s41, s41, 0xffff
s_mov_b32 s42, 2560000
s_mov_b32 s43, 0x00020000
s_add_u32 s48, s22, s72
s_addc_u32 s49, s23, 0
s_add_u32 s48, s48, 10485760
s_addc_u32 s49, s49, 0
s_and_b32 s49, s49, 0xffff
s_mov_b32 s50, 2560000
s_mov_b32 s51, 0x00020000
s_mov_b32 s52, s18
s_mov_b32 s53, s19
s_and_b32 s53, s53, 0xffff
s_mov_b32 s54, 5120000
s_mov_b32 s55, 0x00020000
s_mov_b32 s56, s16
s_mov_b32 s57, s17
s_and_b32 s57, s57, 0xffff
s_mov_b32 s58, 270336
s_mov_b32 s59, 0x00020000
v_lshlrev_b32 v3, 2, v2
v_and_b32 v20, 3, v2
v_lshlrev_b32 v20, 4, v20
v_lshrrev_b32 v21, 2, v2
v_add_u32 v20, v20, v21
s_lshl_b32 s72, s85, 6
v_add_u32 v20, s72, v20
v_lshlrev_b32 v20, 1, v20
s_mov_b32 s72, 262144
buffer_load_ushort v32, v20, s[56:59], s72 offen
s_add_u32 s72, s72, 512
buffer_load_ushort v33, v20, s[56:59], s72 offen
s_add_u32 s72, s72, 512
buffer_load_ushort v34, v20, s[56:59], s72 offen
s_add_u32 s72, s72, 512
buffer_load_ushort v35, v20, s[56:59], s72 offen
s_add_u32 s72, s72, 512
buffer_load_ushort v36, v20, s[56:59], s72 offen
s_add_u32 s72, s72, 512
buffer_load_ushort v37, v20, s[56:59], s72 offen
s_add_u32 s72, s72, 512
buffer_load_ushort v38, v20, s[56:59], s72 offen
s_add_u32 s72, s72, 512
buffer_load_ushort v39, v20, s[56:59], s72 offen
s_add_u32 s72, s72, 512
buffer_load_ushort v40, v20, s[56:59], s72 offen
s_add_u32 s72, s72, 512
buffer_load_ushort v41, v20, s[56:59], s72 offen
s_add_u32 s72, s72, 512
buffer_load_ushort v42, v20, s[56:59], s72 offen
s_add_u32 s72, s72, 512
buffer_load_ushort v43, v20, s[56:59], s72 offen
s_add_u32 s72, s72, 512
buffer_load_ushort v44, v20, s[56:59], s72 offen
s_add_u32 s72, s72, 512
buffer_load_ushort v45, v20, s[56:59], s72 offen
s_add_u32 s72, s72, 512
buffer_load_ushort v46, v20, s[56:59], s72 offen
s_add_u32 s72, s72, 512
buffer_load_ushort v47, v20, s[56:59], s72 offen
s_add_u32 s72, s72, 512
s_waitcnt vmcnt(0)
v_lshlrev_b32 v32, 16, v32
v_lshlrev_b32 v33, 16, v33
v_lshlrev_b32 v34, 16, v34
v_lshlrev_b32 v35, 16, v35
v_lshlrev_b32 v36, 16, v36
v_lshlrev_b32 v37, 16, v37
v_lshlrev_b32 v38, 16, v38
v_lshlrev_b32 v39, 16, v39
v_lshlrev_b32 v40, 16, v40
v_lshlrev_b32 v41, 16, v41
v_lshlrev_b32 v42, 16, v42
v_lshlrev_b32 v43, 16, v43
v_lshlrev_b32 v44, 16, v44
v_lshlrev_b32 v45, 16, v45
v_lshlrev_b32 v46, 16, v46
v_lshlrev_b32 v47, 16, v47
s_waitcnt lgkmcnt(0)
s_barrier
s_lshl_b32 s60, s24, 6
K2_SL_LOOP:
v_add_u32 v22, s60, v2
v_lshlrev_b32 v23, 2, v22
buffer_load_dword v24, v23, s[32:35], 0 offen
buffer_load_dword v25, v23, s[36:39], 0 offen
s_waitcnt vmcnt(0)
v_subrev_u32 v24, s87, v24
v_cmp_gt_u32 s[64:65], s88, v24
s_mov_b32 s72, 160000
v_cmp_gt_u32 vcc, s72, v22
s_and_b64 s[64:65], s[64:65], vcc
K2_SL_BITS:
s_cmp_eq_u64 s[64:65], 0
s_cbranch_scc1 K2_SL_NEXT
s_ff1_i32_b64 s72, s[64:65]
s_bitset0_b64 s[64:65], s72
v_readlane_b32 s62, v24, s72
v_readlane_b32 s63, v25, s72
s_add_u32 s61, s60, s72
s_lshl_b32 s61, s61, 5
s_nop 3
s_lshl_b32 s63, s63, 8
s_add_u32 s66, s62, s87
s_lshl_b32 s66, s66, 8
v_mov_b32 v26, 0
buffer_load_dwordx4 v[48:51], v26, s[44:47], s61 offen
buffer_load_dwordx4 v[52:55], v26, s[44:47], s61 offen offset:16
buffer_load_dword v27, v3, s[40:43], s63 offen
buffer_load_dword v28, v3, s[48:51], s66 offen
s_waitcnt vmcnt(0)
v_and_b32 v29, s68, v28
v_lshlrev_b32 v30, 16, v48
v_fma_f32 v29, v30, v32, v29
v_and_b32 v30, s68, v48
v_fma_f32 v29, v30, v33, v29
v_lshlrev_b32 v30, 16, v49
v_fma_f32 v29, v30, v34, v29
v_and_b32 v30, s68, v49
v_fma_f32 v29, v30, v35, v29
v_lshlrev_b32 v30, 16, v50
v_fma_f32 v29, v30, v36, v29
v_and_b32 v30, s68, v50
v_fma_f32 v29, v30, v37, v29
v_lshlrev_b32 v30, 16, v51
v_fma_f32 v29, v30, v38, v29
v_and_b32 v30, s68, v51
v_fma_f32 v29, v30, v39, v29
v_lshlrev_b32 v30, 16, v52
v_fma_f32 v29, v30, v40, v29
v_and_b32 v30, s68, v52
v_fma_f32 v29, v30, v41, v29
v_lshlrev_b32 v30, 16, v53
v_fma_f32 v29, v30, v42, v29
v_and_b32 v30, s68, v53
v_fma_f32 v29, v30, v43, v29
v_lshlrev_b32 v30, 16, v54
v_fma_f32 v29, v30, v44, v29
v_and_b32 v30, s68, v54
v_fma_f32 v29, v30, v45, v29
v_lshlrev_b32 v30, 16, v55
v_fma_f32 v29, v30, v46, v29
v_and_b32 v30, s68, v55
v_fma_f32 v29, v30, v47, v29
v_fma_mix_f32 v29, v29, s81, v27 op_sel_hi:[0,0,1]
v_exp_f32 v29, v29
s_nop 0
v_add_f32 v29, 1.0, v29
v_rcp_f32 v29, v29
s_lshl_b32 s72, s62, 8
v_mul_f32 v29, v29, v27
v_add_u32 v30, s72, v3
ds_add_f32 v30, v29
s_branch K2_SL_BITS
K2_SL_NEXT:
s_add_u32 s60, s60, 1024
s_cmp_lt_u32 s60, 160000
s_cbranch_scc1 K2_SL_LOOP
s_waitcnt lgkmcnt(0)
s_barrier
s_mov_b32 s62, s24
K2_SL_FIN:
s_cmp_ge_u32 s62, s88
s_cbranch_scc1 K_END
s_add_u32 s66, s62, s87
s_lshl_b32 s63, s66, 8
s_lshl_b32 s72, s62, 8
v_add_u32 v30, s72, v3
ds_read_b32 v29, v30
buffer_load_dword v28, v3, s[48:51], s63 offen
s_waitcnt vmcnt(0) lgkmcnt(0)
v_lshlrev_b32 v28, 16, v28
v_add_f32 v28, v28, v29
v_mul_f32 v29, s81, v28
v_exp_f32 v29, v29
s_nop 0
v_add_f32 v29, 1.0, v29
v_rcp_f32 v29, v29
s_lshl_b32 s63, s66, 9
v_mul_f32 v28, v28, v29
v_cvt_pk_bf16_f32 v28, v28, v28
buffer_store_short v28, v20, s[52:55], s63 offen
s_add_u32 s62, s62, 16
s_branch K2_SL_FIN
K_END:
s_endpgm
CODE_END:
.long 0, 0, 0, 0
.section .rodata,"a"
.p2align 6
.amdhsa_kernel mpnn_fused_kernel
  .amdhsa_next_free_vgpr 128
  .amdhsa_next_free_sgpr 102
  .amdhsa_accum_offset 128
  .amdhsa_group_segment_fixed_size 0
  .amdhsa_kernarg_size 80
  .amdhsa_user_sgpr_count 2
  .amdhsa_user_sgpr_kernarg_segment_ptr 1
  .amdhsa_system_sgpr_workgroup_id_x 1
  .amdhsa_float_denorm_mode_32 3
.end_amdhsa_kernel
.text
```
